```python
import torch

def _softmax(x, axis=-1):
    return torch.softmax(x, dim=axis)
def _gelu(x):
    return torch.nn.functional.gelu(x, approximate="tanh")
def _silu(x):
    return torch.nn.functional.silu(x)
def _sigmoid(x):
    return torch.sigmoid(x)
def _layernorm(x, axis=-1, eps=1e-5):
    m = x.mean(dim=axis, keepdim=True)
    v = x.var(dim=axis, keepdim=True, unbiased=False)
    return (x - m) / torch.sqrt(v + eps)
def _scatter_add(tgt, idx, src, axis=0):
    return tgt.clone().index_add_(axis, idx, src)
def _segment_sum(src, seg, n):
    out = torch.zeros((n,) + src.shape[1:], dtype=src.dtype)
    return out.index_add_(0, seg, src)
def _pad(x, pw):
    flat = tuple(v for pair in reversed(pw) for v in pair)
    return torch.nn.functional.pad(x, flat)

kernel_name = 'standalone__mha_block__prompt'

def setup_inputs():

    _w = (lambda a: (lambda t: t.to(torch.bfloat16) if t.is_floating_point() else t)(torch.as_tensor(a)))
    B, S, D, H = 1, 2048, 512, 32
    return {
        "x": _w((lambda *s: torch.randn(*s, dtype=torch.bfloat16) * 0.2)(B, S, D)),
        "wqkv": _w((lambda *s: torch.randn(*s, dtype=torch.bfloat16) * 0.2)(D, 3 * D)),
        "wo": _w((lambda *s: torch.randn(*s, dtype=torch.bfloat16) * 0.05)(D, D)),
    }

def reference(x, wqkv, wo):
    B, S, D = x.shape
    H = 32
    Dh = D // H
    qkv = (lambda x, *d: x.permute(*d))((x @ wqkv).reshape(B, S, 3, H, Dh), 2, 0, 3, 1, 4)
    q, k, v = qkv[0], qkv[1], qkv[2]
    scores = torch.einsum("bhqd,bhkd->bhqk", q, k) * (Dh ** -0.5)
    p = _softmax(scores, axis=-1)
    o = torch.einsum("bhqk,bhkd->bhqd", p, v)
    return (lambda x, *d: x.permute(*d))(o, 0, 2, 1, 3).reshape(B, S, D) @ wo
```

```asm
; @launch grid=(256,1,1) block=(576,1,1) lds=163840
.amdgcn_target "amdgcn-amd-amdhsa--gfx950"
.text
.globl standalone__mha_block__prompt_kernel
.p2align 8
.type standalone__mha_block__prompt_kernel,@function
standalone__mha_block__prompt_kernel:
    s_cmp_ge_u32 s2, 256
    s_cbranch_scc1 Lend
    s_load_dwordx8 s[4:11], s[0:1], 0
    s_load_dwordx4 s[12:15], s[0:1], 32
    s_and_b32 s20, s2, 6
    s_bfe_u32 s16, s2, 0x10003
    s_add_u32 s20, s20, s16
    s_and_b32 s21, s2, 1
    s_lshl_b32 s21, s21, 4
    s_lshr_b32 s16, s2, 4
    s_add_u32 s21, s21, s16
    v_lshrrev_b32 v1, 6, v0
    v_and_b32 v0, 63, v0
    v_lshrrev_b32 v8, 3, v0
    v_readfirstlane_b32 s22, v1
    v_lshlrev_b32 v1, 4, v0
    v_and_b32 v9, 7, v0
    s_add_u32 s51, s21, s20
    s_and_b32 s50, s51, 7
    s_sub_u32 s22, s22, 1
    s_cbranch_scc1 Lhelper
    s_and_b32 s16, s22, 1
    s_lshl_b32 s17, s16, 2
    v_and_b32 v10, 2, v8
    v_xor_b32 v14, v9, v10
    v_xor_b32 v14, s17, v14
    v_lshlrev_b32 v14, 4, v14
    v_mul_u32_u24 v10, 3072, v8
    s_mul_i32 s18, s22, 24576
    s_lshl_b32 s19, s20, 7
    s_add_u32 s18, s18, s19
    v_add3_u32 v14, v14, v10, s18
    s_lshl_b32 s49, s22, 11
    s_waitcnt lgkmcnt(0)
    s_mov_b32 s28, s6
    s_mov_b32 s29, s7
    s_mov_b32 s30, 1572864
    s_mov_b32 s31, 0x20000
    s_lshl_b32 s52, s50, 13
    s_mul_i32 s16, s50, 196608
    s_add_u32 m0, s49, 64512
    s_add_u32 s50, s50, 1
    buffer_load_dwordx4 v14, s[28:31], s16 offen offset:1024 lds
    buffer_load_dwordx4 v14, s[28:31], s16 offen offset:2048 lds
    s_and_b32 s50, s50, 7
    s_getpc_b64 s[18:19]
    s_and_b32 s16, s2, 0xf8
    s_add_u32 s16, s16, s22
    s_lshl_b32 s16, s16, 6
    s_load_dword s3, s[18:19], s16
    s_barrier
    s_mul_i32 s16, s50, 196608
    s_add_u32 m0, s49, 80896
    s_add_u32 s50, s50, 1
    buffer_load_dwordx4 v14, s[28:31], s16 offen offset:1024 lds
    buffer_load_dwordx4 v14, s[28:31], s16 offen offset:2048 lds
    s_and_b32 s50, s50, 7
    s_branch Lcompute
Lhelper:
    s_setprio 3
    v_lshrrev_b32 v10, 1, v8
    v_xor_b32 v2, v9, v10
    v_lshlrev_b32 v2, 4, v2
    v_lshl_add_u32 v2, v8, 10, v2
    s_lshl_b32 s18, s21, 16
    v_add_u32 v2, s18, v2
    v_xor_b32 v3, 64, v2
    v_add_u32 v3, 7168, v3
    v_add_u32 v4, 14336, v2
    v_add_u32 v5, 14336, v3
    v_mov_b32 v11, 0
    s_waitcnt lgkmcnt(0)
    s_mov_b32 s40, s12
    s_mov_b32 s41, s13
    s_mov_b32 s42, 256
    s_mov_b32 s43, 0x20000
    s_cmp_lg_u32 s2, 0
    s_cbranch_scc1 Lnononce
    s_memrealtime s[16:17]
    v_lshlrev_b32 v12, 3, v0
    s_waitcnt lgkmcnt(0)
    s_bitset1_b32 s17, 31
    v_mov_b32 v6, s16
    v_mov_b32 v7, s17
    s_mov_b64 exec, 0xffff
    buffer_store_dwordx2 v[6:7], v12, s[40:43], 0 offen sc1
    s_mov_b64 exec, -1
Lnononce:
    s_mov_b32 s32, s4
    s_mov_b32 s33, s5
    s_mov_b32 s34, 2097152
    s_mov_b32 s35, 0x20000
    s_lshl_b32 s16, s50, 7
    s_lshl_b32 m0, s50, 13
    s_add_u32 s17, s16, 32768
    buffer_load_dwordx4 v2, s[32:35], s16 offen lds
    buffer_load_dwordx4 v3, s[32:35], s16 offen offset:1024 lds
    buffer_load_dwordx4 v4, s[32:35], s16 offen offset:2048 lds
    buffer_load_dwordx4 v5, s[32:35], s16 offen offset:3072 lds
    s_add_u32 m0, m0, 4096
    s_add_u32 s50, s50, 1
    buffer_load_dwordx4 v2, s[32:35], s17 offen lds
    buffer_load_dwordx4 v3, s[32:35], s17 offen offset:1024 lds
    buffer_load_dwordx4 v4, s[32:35], s17 offen offset:2048 lds
    buffer_load_dwordx4 v5, s[32:35], s17 offen offset:3072 lds
    s_and_b32 s50, s50, 7
    s_barrier
    s_call_b64 s[18:19], Lxdma
    v_mov_b32 v10, 163832
    v_lshlrev_b32 v18, 2, v0
    v_add_u32 v18, 163680, v18
    v_mov_b32 v19, -1
    s_mov_b32 exec_hi, 1
    ds_write_b32 v18, v19
    s_mov_b32 exec_hi, -1
    s_lshl_b32 s57, s20, 5
    s_add_u32 s57, s57, s21
    s_lshl_b32 s57, s57, 7
    s_lshl_b32 s16, s20, 12
    s_add_u32 s16, s16, 6291456
    s_and_b32 s17, s21, 15
    s_lshl_b32 s17, s17, 8
    s_add_u32 s16, s16, s17
    s_add_u32 s24, s14, s16
    s_addc_u32 s25, s15, 0
    s_load_dword s26, s[24:25], 0
    s_load_dword s26, s[24:25], 128
    s_barrier
    s_call_b64 s[18:19], Lxdma
    s_mov_b32 s28, s6
    s_mov_b32 s29, s7
    s_mov_b32 s30, 1572864
    s_mov_b32 s31, 0x20000
    v_mul_u32_u24 v13, 3072, v0
    s_mul_i32 s16, s21, 49152
    s_lshl_b32 s17, s20, 7
    s_add_u32 s16, s16, s17
    s_mov_b64 exec, 0xffff
    buffer_load_dword v14, v13, s[28:31], s16 offen
    s_mov_b64 exec, -1
    s_add_u32 s36, s14, 4194304
    s_addc_u32 s37, s15, 0
    s_mov_b32 s38, 2097152
    s_mov_b32 s39, 0x20000
    s_add_u32 s60, s14, 6291456
    s_addc_u32 s61, s15, 0
    s_mov_b32 s62, 32768
    s_mov_b32 s63, 0x20000
    v_mov_b32 v16, -1
    v_mov_b32 v17, -1
    v_mov_b32 v18, -1
    s_lshl_b32 s27, s21, 16
    s_lshl_b32 s16, s20, 12
    s_add_u32 s27, s27, s16
    v_xor_b32 v20, s21, v0
    v_lshlrev_b32 v13, 7, v20
    v_lshlrev_b32 v20, 12, v20
    s_lshl_b32 s56, s20, 12
    s_waitcnt vmcnt(17)
    s_barrier
    s_call_b64 s[18:19], Lxdma
    s_waitcnt vmcnt(17)
    s_barrier
    s_call_b64 s[18:19], Lxdma
    s_waitcnt vmcnt(17)
    s_barrier
    s_call_b64 s[18:19], Lxdma
    s_waitcnt vmcnt(16)
    s_barrier
    s_call_b64 s[18:19], Lxdma
    s_waitcnt vmcnt(16)
    s_barrier
    s_call_b64 s[18:19], Lxdma
    buffer_load_dwordx2 v[6:7], v11, s[40:43], 0 offen sc1
    buffer_store_dwordx4 v[16:19], v1, s[36:39], s27 offen sc1
    buffer_store_dwordx4 v[16:19], v1, s[36:39], s27 offen offset:1024 sc1
    buffer_store_dwordx4 v[16:19], v1, s[36:39], s27 offen offset:2048 sc1
    buffer_store_dwordx4 v[16:19], v1, s[36:39], s27 offen offset:3072 sc1
    s_add_u32 s27, s27, 32768
    buffer_store_dwordx4 v[16:19], v1, s[36:39], s27 offen sc1
    buffer_store_dwordx4 v[16:19], v1, s[36:39], s27 offen offset:1024 sc1
    buffer_store_dwordx4 v[16:19], v1, s[36:39], s27 offen offset:2048 sc1
    buffer_store_dwordx4 v[16:19], v1, s[36:39], s27 offen offset:3072 sc1
    s_add_u32 s27, s27, 32768
    s_waitcnt vmcnt(25)
    s_barrier
    s_waitcnt vmcnt(17)
    s_barrier
    s_waitcnt vmcnt(9)
    s_barrier
    s_barrier
    s_mov_b32 s54, 200000
    s_mov_b32 s48, 1
    s_mov_b32 s49, 163684
    s_waitcnt vmcnt(0)
Lhn:
    v_cmp_eq_u64 vcc, 0, v[6:7]
    s_sub_u32 s54, s54, 1
    s_cbranch_scc1 Lhn2
    s_cbranch_vccz Lhn2
    buffer_load_dwordx2 v[6:7], v11, s[40:43], 0 offen sc1
    s_waitcnt vmcnt(0)
    s_branch Lhn
Lhn2:
    ds_write_b64 v10, v[6:7]
    s_barrier
    s_barrier
    s_mov_b64 exec, 1
    buffer_store_dwordx2 v[6:7], v11, s[60:63], s57 offen sc1
    s_mov_b32 exec_lo, -1
    buffer_load_dwordx2 v[14:15], v13, s[60:63], s56 offen sc1
    s_barrier
    s_waitcnt vmcnt(0)
    v_cmp_eq_u64 vcc, v[6:7], v[14:15]
    buffer_load_dwordx2 v[14:15], v13, s[60:63], s56 offen sc1
    s_andn2_b32 s16, vcc_lo, s48
    s_cbranch_scc0 Lhq
    s_or_b32 s48, s48, s16
    v_mbcnt_lo_u32_b32 v16, s16, 0
    v_lshl_add_u32 v16, v16, 2, s49
    s_mov_b32 exec_lo, s16
    ds_write_b32 v16, v20
    s_mov_b32 exec_lo, -1
    s_bcnt1_i32_b32 s16, s16
    s_lshl_b32 s16, s16, 2
    s_add_u32 s49, s49, s16
Lhq:
    s_mov_b32 s54, 200000
    s_waitcnt lgkmcnt(0)
    s_barrier
Lhp:
    s_waitcnt vmcnt(0)
    v_cmp_eq_u64 vcc, v[6:7], v[14:15]
    buffer_load_dwordx2 v[14:15], v13, s[60:63], s56 offen sc1
    s_sub_u32 s54, s54, 1
    s_cselect_b32 vcc_lo, -1, vcc_lo
    s_andn2_b32 s16, vcc_lo, s48
    s_cbranch_scc0 Lhp2
    s_or_b32 s48, s48, s16
    v_mbcnt_lo_u32_b32 v16, s16, 0
    v_lshl_add_u32 v16, v16, 2, s49
    s_mov_b32 exec_lo, s16
    ds_write_b32 v16, v20
    s_mov_b32 exec_lo, -1
    s_bcnt1_i32_b32 s16, s16
    s_lshl_b32 s16, s16, 2
    s_add_u32 s49, s49, s16
Lhp2:
    s_cmp_lg_u32 s48, -1
    s_cbranch_scc1 Lhp
    s_lshl_b32 s16, s2, 11
    s_add_u32 s24, s8, s16
    s_addc_u32 s25, s9, 0
    s_load_dword s26, s[24:25], 0
    s_load_dword s26, s[24:25], 64
    s_load_dword s26, s[24:25], 128
    s_load_dword s26, s[24:25], 192
    s_load_dword s26, s[24:25], 256
    s_load_dword s26, s[24:25], 320
    s_load_dword s26, s[24:25], 384
    s_load_dword s26, s[24:25], 448
    s_load_dword s26, s[24:25], 512
    s_load_dword s26, s[24:25], 576
    s_load_dword s26, s[24:25], 640
    s_load_dword s26, s[24:25], 704
    s_load_dword s26, s[24:25], 768
    s_load_dword s26, s[24:25], 832
    s_load_dword s26, s[24:25], 896
    s_load_dword s26, s[24:25], 960
    s_load_dword s26, s[24:25], 1024
    s_load_dword s26, s[24:25], 1088
    s_load_dword s26, s[24:25], 1152
    s_load_dword s26, s[24:25], 1216
    s_load_dword s26, s[24:25], 1280
    s_load_dword s26, s[24:25], 1344
    s_load_dword s26, s[24:25], 1408
    s_load_dword s26, s[24:25], 1472
    s_load_dword s26, s[24:25], 1536
    s_load_dword s26, s[24:25], 1600
    s_load_dword s26, s[24:25], 1664
    s_load_dword s26, s[24:25], 1728
    s_load_dword s26, s[24:25], 1792
    s_load_dword s26, s[24:25], 1856
    s_load_dword s26, s[24:25], 1920
    s_load_dword s26, s[24:25], 1984
    s_endpgm
Lxdma:
    s_lshl_b32 s16, s50, 7
    s_lshl_b32 m0, s50, 13
    s_add_u32 s17, s16, 32768
    buffer_load_dwordx4 v2, s[32:35], s16 offen lds
    buffer_load_dwordx4 v3, s[32:35], s16 offen offset:1024 lds
    buffer_load_dwordx4 v4, s[32:35], s16 offen offset:2048 lds
    buffer_load_dwordx4 v5, s[32:35], s16 offen offset:3072 lds
    s_add_u32 m0, m0, 4096
    s_add_u32 s50, s50, 1
    buffer_load_dwordx4 v2, s[32:35], s17 offen lds
    buffer_load_dwordx4 v3, s[32:35], s17 offen offset:1024 lds
    buffer_load_dwordx4 v4, s[32:35], s17 offen offset:2048 lds
    buffer_load_dwordx4 v5, s[32:35], s17 offen offset:3072 lds
    s_and_b32 s50, s50, 7
    s_setpc_b64 s[18:19]
.p2align 6
Lcompute:
    s_and_b32 s51, s51, 3
    s_lshl_b32 s55, s51, 14
    s_add_u32 s36, s14, 4194304
    s_addc_u32 s37, s15, 0
    s_mov_b32 s38, 2097152
    s_mov_b32 s39, 0x20000
    s_add_u32 s60, s14, 6291456
    s_addc_u32 s61, s15, 0
    s_mov_b32 s62, 32768
    s_mov_b32 s63, 0x20000
    s_mov_b32 s32, s14
    s_mov_b32 s33, s15
    s_mov_b32 s34, 4194304
    s_mov_b32 s35, 0x20000
    s_mov_b32 s40, s8
    s_mov_b32 s41, s9
    s_mov_b32 s42, 524288
    s_mov_b32 s43, 0x20000
    s_and_b32 s23, s22, 3
    s_lshr_b32 s24, s22, 2
    s_lshl_b32 s25, s20, 2
    s_add_u32 s25, s25, s23
    s_lshl_b32 s26, s21, 1
    s_add_u32 s26, s26, s24
    s_lshl_b32 s27, s26, 5
    s_add_u32 s27, s27, s25
    s_lshl_b32 s27, s27, 10
    s_lshl_b32 s58, s25, 6
    s_add_u32 s58, s58, s26
    s_lshl_b32 s58, s58, 11
    v_lshrrev_b32 v2, 4, v0
    v_and_b32 v3, 15, v0
    v_bfe_u32 v16, v0, 2, 2
    v_lshlrev_b32 v15, 11, v2
    v_lshl_add_u32 v15, v16, 7, v15
    v_lshrrev_b32 v16, 1, v16
    v_and_b32 v17, 1, v2
    v_lshl_add_u32 v16, v17, 1, v16
    v_xor_b32 v16, s23, v16
    v_lshl_add_u32 v15, v16, 5, v15
    v_and_b32 v16, 3, v0
    v_lshl_add_u32 v15, v16, 3, v15
    v_add_u32 v15, 65536, v15
    v_lshrrev_b32 v16, 1, v3
    v_xor_b32 v16, v16, v2
    v_lshlrev_b32 v16, 4, v16
    v_lshl_add_u32 v18, v3, 7, v16
    s_lshl_b32 s16, s24, 12
    v_add_u32 v18, s16, v18
    v_xor_b32 v19, 64, v18
    s_barrier
    s_mul_i32 s16, s50, 196608
    s_add_u32 m0, s49, 97280
    s_add_u32 s50, s50, 1
    buffer_load_dwordx4 v14, s[28:31], s16 offen offset:1024 lds
    buffer_load_dwordx4 v14, s[28:31], s16 offen offset:2048 lds
    s_and_b32 s50, s50, 7
    v_and_b32 v4, 11, v0
    v_cmp_eq_u32 vcc, 0, v4
    v_mov_b32 v5, 0x3f803f80
    s_mov_b32 s44, 0x0000ffff
    s_mov_b32 s45, 0x0000ffff
    v_cndmask_b32 v152, 0, v5, vcc
    v_mov_b64 v[148:149], 0
    v_mov_b64 v[150:151], 0
    v_mov_b32 v153, v152
    v_lshlrev_b32 v11, 1, v2
    v_xor_b32 v11, v11, v0
    v_and_b32 v11, 15, v11
    v_lshlrev_b32 v11, 4, v11
    v_lshl_add_u32 v10, v2, 10, v11
    s_and_b32 s16, s20, 3
    s_lshl_b32 s16, s16, 8
    s_lshl_b32 s17, s22, 16
    s_add_u32 s16, s16, s17
    v_add_u32 v10, s16, v10
    v_xor_b32 v11, 128, v10
    v_add_u32 v11, 3072, v11
    s_lshl_b32 s48, s22, 14
    s_and_b32 s53, s21, 3
    s_lshl_b32 s53, s53, 14
    s_lshl_b32 s16, s21, 7
    v_lshl_add_u32 v12, v0, 12, s16
    s_xor_b32 s17, s22, 4
    s_lshl_b32 s17, s17, 12
    s_lshl_b32 s18, s22, 12
    v_add_u32 v2, s17, v1
    v_add_u32 v3, s18, v1
    v_add_u32 v2, 131072, v2
    v_add_u32 v3, 131072, v3
    v_mov_b32 v4, 163680
    v_mov_b32 v5, 163832
    v_mov_b32 v8, 0xdddddddd
    s_lshl_b32 s16, s25, 17
    s_lshl_b32 s17, s24, 11
    s_add_u32 s16, s16, s17
    v_add_u32 v9, s16, v1
    s_mov_b32 s46, 1052289595
    s_mov_b32 s47, 0
    s_mov_b32 s59, 124
    v_lshlrev_b32 v13, 7, v0
    v_mov_b64 v[20:21], 0
    v_mov_b64 v[22:23], 0
    v_mov_b64 v[24:25], 0
    v_mov_b64 v[26:27], 0
    v_mov_b64 v[28:29], 0
    v_mov_b64 v[30:31], 0
    v_mov_b64 v[32:33], 0
    v_mov_b64 v[34:35], 0
    v_mov_b64 v[36:37], 0
    v_mov_b64 v[38:39], 0
    v_mov_b64 v[40:41], 0
    v_mov_b64 v[42:43], 0
    v_add_u32 v16, s52, v18
    v_add_u32 v17, s52, v19
    s_add_u32 s52, s52, 8192
    s_and_b32 s52, s52, 0xffff
    s_waitcnt vmcnt(4) lgkmcnt(0)
    s_barrier
    ds_read_b128 v[44:47], v16
    ds_read_b128 v[48:51], v16 offset:2048
    ds_read_b64_tr_b16 v[60:61], v15
    ds_read_b64_tr_b16 v[62:63], v15 offset:512
    ds_read_b64_tr_b16 v[64:65], v15 offset:1024
    ds_read_b64_tr_b16 v[66:67], v15 offset:1536
    ds_read_b128 v[52:55], v17
    ds_read_b128 v[56:59], v17 offset:2048
    ds_read_b64_tr_b16 v[68:69], v15 offset:8192
    ds_read_b64_tr_b16 v[70:71], v15 offset:8704
    ds_read_b64_tr_b16 v[72:73], v15 offset:9216
    ds_read_b64_tr_b16 v[74:75], v15 offset:9728
    s_mul_i32 s16, s50, 196608
    s_add_u32 m0, s49, 113664
    s_add_u32 s50, s50, 1
    buffer_load_dwordx4 v14, s[28:31], s16 offen offset:1024 lds
    buffer_load_dwordx4 v14, s[28:31], s16 offen offset:2048 lds
    s_and_b32 s50, s50, 7
    v_add_u32 v16, s52, v18
    v_add_u32 v17, s52, v19
    s_add_u32 s52, s52, 8192
    s_and_b32 s52, s52, 0xffff
    s_waitcnt vmcnt(4) lgkmcnt(0)
    s_barrier
    v_mfma_f32_16x16x32_bf16 v[20:23], v[60:63], v[44:47], v[20:23]
    ds_read_b128 v[104:107], v16
    ds_read_b128 v[108:111], v16 offset:2048
    v_mfma_f32_16x16x32_bf16 v[32:35], v[60:63], v[48:51], v[32:35]
    ds_read_b64_tr_b16 v[120:121], v15 offset:16384
    ds_read_b64_tr_b16 v[122:123], v15 offset:16896
    v_mfma_f32_16x16x32_bf16 v[24:27], v[44:47], v[64:67], v[24:27]
    ds_read_b64_tr_b16 v[124:125], v15 offset:17408
    ds_read_b64_tr_b16 v[126:127], v15 offset:17920
    v_mfma_f32_16x16x32_bf16 v[36:39], v[48:51], v[64:67], v[36:39]
    ds_read_b128 v[112:115], v17
    ds_read_b128 v[116:119], v17 offset:2048
    v_mfma_f32_16x16x32_bf16 v[20:23], v[68:71], v[52:55], v[20:23]
    ds_read_b64_tr_b16 v[128:129], v15 offset:24576
    ds_read_b64_tr_b16 v[130:131], v15 offset:25088
    v_mfma_f32_16x16x32_bf16 v[32:35], v[68:71], v[56:59], v[32:35]
    ds_read_b64_tr_b16 v[132:133], v15 offset:25600
    ds_read_b64_tr_b16 v[134:135], v15 offset:26112
    v_mfma_f32_16x16x32_bf16 v[24:27], v[52:55], v[72:75], v[24:27]
    s_mul_i32 s16, s50, 196608
    s_add_u32 m0, s49, 64512
    s_add_u32 s50, s50, 1
    buffer_load_dwordx4 v14, s[28:31], s16 offen offset:1024 lds
    buffer_load_dwordx4 v14, s[28:31], s16 offen offset:2048 lds
    s_and_b32 s50, s50, 7
    v_mfma_f32_16x16x32_bf16 v[36:39], v[56:59], v[72:75], v[36:39]
    v_add_u32 v16, s52, v18
    v_add_u32 v17, s52, v19
    s_add_u32 s52, s52, 8192
    s_and_b32 s52, s52, 0xffff
    s_waitcnt vmcnt(4) lgkmcnt(0)
    s_barrier
    v_mfma_f32_16x16x32_bf16 v[20:23], v[120:123], v[104:107], v[20:23]
    ds_read_b128 v[44:47], v16
    ds_read_b128 v[48:51], v16 offset:2048
    v_mfma_f32_16x16x32_bf16 v[32:35], v[120:123], v[108:111], v[32:35]
    ds_read_b64_tr_b16 v[60:61], v15 offset:32768
    ds_read_b64_tr_b16 v[62:63], v15 offset:33280
    v_mfma_f32_16x16x32_bf16 v[24:27], v[104:107], v[124:127], v[24:27]
    ds_read_b64_tr_b16 v[64:65], v15 offset:33792
    ds_read_b64_tr_b16 v[66:67], v15 offset:34304
    v_mfma_f32_16x16x32_bf16 v[36:39], v[108:111], v[124:127], v[36:39]
    ds_read_b128 v[52:55], v17
    ds_read_b128 v[56:59], v17 offset:2048
    v_mfma_f32_16x16x32_bf16 v[20:23], v[128:131], v[112:115], v[20:23]
    ds_read_b64_tr_b16 v[68:69], v15 offset:40960
    ds_read_b64_tr_b16 v[70:71], v15 offset:41472
    v_mfma_f32_16x16x32_bf16 v[32:35], v[128:131], v[116:119], v[32:35]
    ds_read_b64_tr_b16 v[72:73], v15 offset:41984
    ds_read_b64_tr_b16 v[74:75], v15 offset:42496
    v_mfma_f32_16x16x32_bf16 v[24:27], v[112:115], v[132:135], v[24:27]
    s_mul_i32 s16, s50, 196608
    s_add_u32 m0, s49, 80896
    s_add_u32 s50, s50, 1
    buffer_load_dwordx4 v14, s[28:31], s16 offen offset:1024 lds
    buffer_load_dwordx4 v14, s[28:31], s16 offen offset:2048 lds
    s_and_b32 s50, s50, 7
    v_mfma_f32_16x16x32_bf16 v[36:39], v[116:119], v[132:135], v[36:39]
    v_add_u32 v16, s52, v18
    v_add_u32 v17, s52, v19
    s_add_u32 s52, s52, 8192
    s_and_b32 s52, s52, 0xffff
    s_waitcnt vmcnt(4) lgkmcnt(0)
    s_barrier
    v_mfma_f32_16x16x32_bf16 v[20:23], v[60:63], v[44:47], v[20:23]
    ds_read_b128 v[104:107], v16
    ds_read_b128 v[108:111], v16 offset:2048
    v_mfma_f32_16x16x32_bf16 v[32:35], v[60:63], v[48:51], v[32:35]
    ds_read_b64_tr_b16 v[120:121], v15 offset:49152
    ds_read_b64_tr_b16 v[122:123], v15 offset:49664
    v_mfma_f32_16x16x32_bf16 v[24:27], v[44:47], v[64:67], v[24:27]
    ds_read_b64_tr_b16 v[124:125], v15 offset:50176
    ds_read_b64_tr_b16 v[126:127], v15 offset:50688
    v_mfma_f32_16x16x32_bf16 v[36:39], v[48:51], v[64:67], v[36:39]
    ds_read_b128 v[112:115], v17
    ds_read_b128 v[116:119], v17 offset:2048
    v_mfma_f32_16x16x32_bf16 v[20:23], v[68:71], v[52:55], v[20:23]
    ds_read_b64_tr_b16 v[128:129], v15 offset:57344
    ds_read_b64_tr_b16 v[130:131], v15 offset:57856
    v_mfma_f32_16x16x32_bf16 v[32:35], v[68:71], v[56:59], v[32:35]
    ds_read_b64_tr_b16 v[132:133], v15 offset:58368
    ds_read_b64_tr_b16 v[134:135], v15 offset:58880
    v_mfma_f32_16x16x32_bf16 v[24:27], v[52:55], v[72:75], v[24:27]
    s_mul_i32 s16, s50, 196608
    s_add_u32 m0, s49, 97280
    s_add_u32 s50, s50, 1
    buffer_load_dwordx4 v14, s[28:31], s16 offen offset:1024 lds
    buffer_load_dwordx4 v14, s[28:31], s16 offen offset:2048 lds
    s_and_b32 s50, s50, 7
    v_mfma_f32_16x16x32_bf16 v[36:39], v[56:59], v[72:75], v[36:39]
    v_add_u32 v16, s52, v18
    v_add_u32 v17, s52, v19
    s_add_u32 s52, s52, 8192
    s_and_b32 s52, s52, 0xffff
    s_waitcnt vmcnt(4) lgkmcnt(0)
    s_barrier
    v_mfma_f32_16x16x32_bf16 v[20:23], v[120:123], v[104:107], v[20:23]
    ds_read_b128 v[44:47], v16
    ds_read_b128 v[48:51], v16 offset:2048
    v_mfma_f32_16x16x32_bf16 v[32:35], v[120:123], v[108:111], v[32:35]
    ds_read_b64_tr_b16 v[60:61], v15
    ds_read_b64_tr_b16 v[62:63], v15 offset:512
    v_mfma_f32_16x16x32_bf16 v[24:27], v[104:107], v[124:127], v[24:27]
    ds_read_b64_tr_b16 v[64:65], v15 offset:1024
    ds_read_b64_tr_b16 v[66:67], v15 offset:1536
    v_mfma_f32_16x16x32_bf16 v[36:39], v[108:111], v[124:127], v[36:39]
    ds_read_b128 v[52:55], v17
    ds_read_b128 v[56:59], v17 offset:2048
    v_mfma_f32_16x16x32_bf16 v[20:23], v[128:131], v[112:115], v[20:23]
    ds_read_b64_tr_b16 v[68:69], v15 offset:8192
    ds_read_b64_tr_b16 v[70:71], v15 offset:8704
    v_mfma_f32_16x16x32_bf16 v[32:35], v[128:131], v[116:119], v[32:35]
    ds_read_b64_tr_b16 v[72:73], v15 offset:9216
    ds_read_b64_tr_b16 v[74:75], v15 offset:9728
    v_mfma_f32_16x16x32_bf16 v[24:27], v[112:115], v[132:135], v[24:27]
    s_mul_i32 s16, s50, 196608
    s_add_u32 m0, s49, 113664
    s_add_u32 s50, s50, 1
    buffer_load_dwordx4 v14, s[28:31], s16 offen offset:1024 lds
    buffer_load_dwordx4 v14, s[28:31], s16 offen offset:2048 lds
    s_and_b32 s50, s50, 7
    v_mfma_f32_16x16x32_bf16 v[36:39], v[116:119], v[132:135], v[36:39]
    v_add_u32 v16, s52, v18
    v_add_u32 v17, s52, v19
    s_add_u32 s52, s52, 8192
    s_and_b32 s52, s52, 0xffff
    s_waitcnt vmcnt(4) lgkmcnt(0)
    s_barrier
    v_mfma_f32_16x16x32_bf16 v[20:23], v[60:63], v[44:47], v[20:23]
    ds_read_b128 v[104:107], v16
    ds_read_b128 v[108:111], v16 offset:2048
    v_mfma_f32_16x16x32_bf16 v[32:35], v[60:63], v[48:51], v[32:35]
    ds_read_b64_tr_b16 v[120:121], v15 offset:16384
    ds_read_b64_tr_b16 v[122:123], v15 offset:16896
    v_mfma_f32_16x16x32_bf16 v[24:27], v[44:47], v[64:67], v[24:27]
    ds_read_b64_tr_b16 v[124:125], v15 offset:17408
    ds_read_b64_tr_b16 v[126:127], v15 offset:17920
    v_mfma_f32_16x16x32_bf16 v[36:39], v[48:51], v[64:67], v[36:39]
    ds_read_b128 v[112:115], v17
    ds_read_b128 v[116:119], v17 offset:2048
    v_mfma_f32_16x16x32_bf16 v[20:23], v[68:71], v[52:55], v[20:23]
    ds_read_b64_tr_b16 v[128:129], v15 offset:24576
    ds_read_b64_tr_b16 v[130:131], v15 offset:25088
    v_mfma_f32_16x16x32_bf16 v[32:35], v[68:71], v[56:59], v[32:35]
    ds_read_b64_tr_b16 v[132:133], v15 offset:25600
    ds_read_b64_tr_b16 v[134:135], v15 offset:26112
    v_mfma_f32_16x16x32_bf16 v[24:27], v[52:55], v[72:75], v[24:27]
    s_mul_i32 s16, s51, 393216
    s_add_u32 m0, s49, 65536
    s_add_u32 s17, s16, 195584
    buffer_load_dwordx4 v14, s[28:31], s16 offen lds
    s_add_u32 s51, s51, 1
    buffer_load_dwordx4 v14, s[28:31], s17 offen offset:1024 lds
    s_and_b32 s51, s51, 3
    v_mfma_f32_16x16x32_bf16 v[36:39], v[56:59], v[72:75], v[36:39]
    v_add_u32 v16, s52, v18
    v_add_u32 v17, s52, v19
    s_add_u32 s52, s52, 8192
    s_and_b32 s52, s52, 0xffff
    s_waitcnt vmcnt(4) lgkmcnt(0)
    s_barrier
    v_mfma_f32_16x16x32_bf16 v[20:23], v[120:123], v[104:107], v[20:23]
    ds_read_b128 v[44:47], v16
    ds_read_b128 v[48:51], v16 offset:2048
    v_mfma_f32_16x16x32_bf16 v[32:35], v[120:123], v[108:111], v[32:35]
    ds_read_b64_tr_b16 v[60:61], v15 offset:32768
    ds_read_b64_tr_b16 v[62:63], v15 offset:33280
    v_mfma_f32_16x16x32_bf16 v[24:27], v[104:107], v[124:127], v[24:27]
    ds_read_b64_tr_b16 v[64:65], v15 offset:33792
    ds_read_b64_tr_b16 v[66:67], v15 offset:34304
    v_mfma_f32_16x16x32_bf16 v[36:39], v[108:111], v[124:127], v[36:39]
    ds_read_b128 v[52:55], v17
    ds_read_b128 v[56:59], v17 offset:2048
    v_mfma_f32_16x16x32_bf16 v[20:23], v[128:131], v[112:115], v[20:23]
    ds_read_b64_tr_b16 v[68:69], v15 offset:40960
    ds_read_b64_tr_b16 v[70:71], v15 offset:41472
    v_mfma_f32_16x16x32_bf16 v[32:35], v[128:131], v[116:119], v[32:35]
    ds_read_b64_tr_b16 v[72:73], v15 offset:41984
    ds_read_b64_tr_b16 v[74:75], v15 offset:42496
    v_mfma_f32_16x16x32_bf16 v[24:27], v[112:115], v[132:135], v[24:27]
    s_mul_i32 s16, s51, 393216
    s_add_u32 m0, s49, 81920
    s_add_u32 s17, s16, 195584
    buffer_load_dwordx4 v14, s[28:31], s16 offen lds
    s_add_u32 s51, s51, 1
    buffer_load_dwordx4 v14, s[28:31], s17 offen offset:1024 lds
    s_and_b32 s51, s51, 3
    v_mfma_f32_16x16x32_bf16 v[36:39], v[116:119], v[132:135], v[36:39]
    v_add_u32 v16, s52, v18
    v_add_u32 v17, s52, v19
    s_add_u32 s52, s52, 8192
    s_and_b32 s52, s52, 0xffff
    s_waitcnt vmcnt(4) lgkmcnt(0)
    s_barrier
    v_mfma_f32_16x16x32_bf16 v[20:23], v[60:63], v[44:47], v[20:23]
    ds_read_b128 v[104:107], v16
    ds_read_b128 v[108:111], v16 offset:2048
    v_mfma_f32_16x16x32_bf16 v[32:35], v[60:63], v[48:51], v[32:35]
    ds_read_b64_tr_b16 v[120:121], v15 offset:49152
    ds_read_b64_tr_b16 v[122:123], v15 offset:49664
    v_mfma_f32_16x16x32_bf16 v[24:27], v[44:47], v[64:67], v[24:27]
    ds_read_b64_tr_b16 v[124:125], v15 offset:50176
    ds_read_b64_tr_b16 v[126:127], v15 offset:50688
    v_mfma_f32_16x16x32_bf16 v[36:39], v[48:51], v[64:67], v[36:39]
    ds_read_b128 v[112:115], v17
    ds_read_b128 v[116:119], v17 offset:2048
    v_mfma_f32_16x16x32_bf16 v[20:23], v[68:71], v[52:55], v[20:23]
    ds_read_b64_tr_b16 v[128:129], v15 offset:57344
    ds_read_b64_tr_b16 v[130:131], v15 offset:57856
    v_mfma_f32_16x16x32_bf16 v[32:35], v[68:71], v[56:59], v[32:35]
    ds_read_b64_tr_b16 v[132:133], v15 offset:58368
    ds_read_b64_tr_b16 v[134:135], v15 offset:58880
    v_mfma_f32_16x16x32_bf16 v[24:27], v[52:55], v[72:75], v[24:27]
    s_mul_i32 s16, s51, 393216
    s_add_u32 m0, s49, 98304
    s_add_u32 s17, s16, 195584
    buffer_load_dwordx4 v14, s[28:31], s16 offen lds
    s_add_u32 s51, s51, 1
    buffer_load_dwordx4 v14, s[28:31], s17 offen offset:1024 lds
    s_and_b32 s51, s51, 3
    v_mfma_f32_16x16x32_bf16 v[36:39], v[56:59], v[72:75], v[36:39]
    s_waitcnt lgkmcnt(6)
    v_mfma_f32_16x16x32_bf16 v[20:23], v[120:123], v[104:107], v[20:23]
    v_mfma_f32_16x16x32_bf16 v[32:35], v[120:123], v[108:111], v[32:35]
    v_mfma_f32_16x16x32_bf16 v[24:27], v[104:107], v[124:127], v[24:27]
    v_mfma_f32_16x16x32_bf16 v[36:39], v[108:111], v[124:127], v[36:39]
    s_waitcnt lgkmcnt(0)
    v_mfma_f32_16x16x32_bf16 v[20:23], v[128:131], v[112:115], v[20:23]
    v_mfma_f32_16x16x32_bf16 v[32:35], v[128:131], v[116:119], v[32:35]
    v_mfma_f32_16x16x32_bf16 v[24:27], v[112:115], v[132:135], v[24:27]
    v_mfma_f32_16x16x32_bf16 v[36:39], v[116:119], v[132:135], v[36:39]
    v_add_u32 v16, s55, v18
    v_add_u32 v17, s55, v19
    s_add_u32 s55, s55, 16384
    s_and_b32 s55, s55, 0xffff
    v_mov_b64 v[100:101], v[152:153]
    v_mov_b64 v[102:103], v[152:153]
    s_nop 1
    v_cvt_pk_bf16_f32 v92, v20, v21
    v_cvt_pk_bf16_f32 v93, v22, v23
    v_cvt_pk_bf16_f32 v94, v32, v33
    v_cvt_pk_bf16_f32 v95, v34, v35
    v_cvt_pk_bf16_f32 v140, v24, v25
    v_cvt_pk_bf16_f32 v141, v26, v27
    v_cvt_pk_bf16_f32 v142, v36, v37
    v_cvt_pk_bf16_f32 v143, v38, v39
    s_nop 0
    v_permlane16_swap_b32 v92, v94
    v_permlane16_swap_b32 v93, v95
    v_permlane16_swap_b32 v140, v142
    v_permlane16_swap_b32 v141, v143
    buffer_store_dwordx4 v[92:95], v1, s[32:35], s58 offen sc1
    buffer_store_dwordx4 v[140:143], v1, s[32:35], s58 offen offset:1024 sc1
    s_waitcnt vmcnt(6)
    s_barrier
    ds_read_b128 v[44:47], v16
    ds_read_b128 v[48:51], v16 offset:2048
    ds_read_b64_tr_b16 v[60:61], v15
    ds_read_b64_tr_b16 v[62:63], v15 offset:512
    ds_read_b128 v[52:55], v17
    ds_read_b128 v[56:59], v17 offset:2048
    ds_read_b64_tr_b16 v[64:65], v15 offset:8192
    ds_read_b64_tr_b16 v[66:67], v15 offset:8704
    s_mul_i32 s16, s51, 393216
    s_add_u32 m0, s49, 114688
    s_add_u32 s17, s16, 195584
    buffer_load_dwordx4 v14, s[28:31], s16 offen lds
    s_add_u32 s51, s51, 1
    buffer_load_dwordx4 v14, s[28:31], s17 offen offset:1024 lds
    s_and_b32 s51, s51, 3
    v_mov_b64 v[96:97], v[140:141]
    v_mov_b64 v[98:99], v[142:143]
    v_mov_b64 v[108:109], v[152:153]
    v_mov_b64 v[110:111], v[152:153]
    v_mov_b64 v[112:113], v[152:153]
    v_mov_b64 v[114:115], v[152:153]
    v_mov_b64 v[120:121], v[152:153]
    v_mov_b64 v[122:123], v[152:153]
    v_mov_b64 v[124:125], v[152:153]
    v_mov_b64 v[126:127], v[152:153]
    v_mov_b64 v[132:133], v[152:153]
    v_mov_b64 v[134:135], v[152:153]
    v_mov_b64 v[136:137], v[152:153]
    v_mov_b64 v[138:139], v[152:153]
    v_permlane16_swap_b32 v96, v100
    v_permlane16_swap_b32 v97, v101
    v_permlane16_swap_b32 v98, v102
    v_permlane16_swap_b32 v99, v103
    s_waitcnt lgkmcnt(0)
    v_mfma_f32_16x16x32_bf16 v[28:31], v[60:63], v[44:47], v[28:31]
    ds_read_b128 v[68:71], v16 offset:8192
    ds_read_b128 v[72:75], v16 offset:10240
    v_mfma_f32_16x16x32_bf16 v[40:43], v[60:63], v[48:51], v[40:43]
    ds_read_b64_tr_b16 v[84:85], v15 offset:1024
    ds_read_b64_tr_b16 v[86:87], v15 offset:1536
    v_mfma_f32_16x16x32_bf16 v[28:31], v[64:67], v[52:55], v[28:31]
    ds_read_b128 v[76:79], v17 offset:8192
    ds_read_b128 v[80:83], v17 offset:10240
    v_mfma_f32_16x16x32_bf16 v[40:43], v[64:67], v[56:59], v[40:43]
    ds_read_b64_tr_b16 v[88:89], v15 offset:9216
    ds_read_b64_tr_b16 v[90:91], v15 offset:9728
    v_add_u32 v16, s55, v18
    v_add_u32 v17, s55, v19
    s_add_u32 s55, s55, 16384
    s_and_b32 s55, s55, 0xffff
    s_waitcnt vmcnt(6) lgkmcnt(0)
    s_barrier
    v_mfma_f32_16x16x32_bf16 v[28:31], v[84:87], v[68:71], v[28:31]
    ds_read_b128 v[44:47], v16
    ds_read_b128 v[48:51], v16 offset:2048
    v_mfma_f32_16x16x32_bf16 v[40:43], v[84:87], v[72:75], v[40:43]
    ds_read_b64_tr_b16 v[60:61], v15 offset:16384
    ds_read_b64_tr_b16 v[62:63], v15 offset:16896
    v_mfma_f32_16x16x32_bf16 v[28:31], v[88:91], v[76:79], v[28:31]
    ds_read_b128 v[52:55], v17
    ds_read_b128 v[56:59], v17 offset:2048
    v_mfma_f32_16x16x32_bf16 v[40:43], v[88:91], v[80:83], v[40:43]
    ds_read_b64_tr_b16 v[64:65], v15 offset:24576
    ds_read_b64_tr_b16 v[66:67], v15 offset:25088
    s_waitcnt lgkmcnt(0)
    v_mfma_f32_16x16x32_bf16 v[28:31], v[60:63], v[44:47], v[28:31]
    ds_read_b128 v[68:71], v16 offset:8192
    ds_read_b128 v[72:75], v16 offset:10240
    v_mfma_f32_16x16x32_bf16 v[40:43], v[60:63], v[48:51], v[40:43]
    ds_read_b64_tr_b16 v[84:85], v15 offset:17408
    ds_read_b64_tr_b16 v[86:87], v15 offset:17920
    v_mfma_f32_16x16x32_bf16 v[28:31], v[64:67], v[52:55], v[28:31]
    ds_read_b128 v[76:79], v17 offset:8192
    ds_read_b128 v[80:83], v17 offset:10240
    v_mfma_f32_16x16x32_bf16 v[40:43], v[64:67], v[56:59], v[40:43]
    ds_read_b64_tr_b16 v[88:89], v15 offset:25600
    ds_read_b64_tr_b16 v[90:91], v15 offset:26112
    v_add_u32 v16, s55, v18
    v_add_u32 v17, s55, v19
    s_add_u32 s55, s55, 16384
    s_and_b32 s55, s55, 0xffff
    s_waitcnt vmcnt(2) lgkmcnt(0)
    s_barrier
    v_mfma_f32_16x16x32_bf16 v[28:31], v[84:87], v[68:71], v[28:31]
    ds_read_b128 v[44:47], v16
    ds_read_b128 v[48:51], v16 offset:2048
    v_mfma_f32_16x16x32_bf16 v[40:43], v[84:87], v[72:75], v[40:43]
    ds_read_b64_tr_b16 v[60:61], v15 offset:32768
    ds_read_b64_tr_b16 v[62:63], v15 offset:33280
    v_mfma_f32_16x16x32_bf16 v[28:31], v[88:91], v[76:79], v[28:31]
    ds_read_b128 v[52:55], v17
    ds_read_b128 v[56:59], v17 offset:2048
    v_mfma_f32_16x16x32_bf16 v[40:43], v[88:91], v[80:83], v[40:43]
    ds_read_b64_tr_b16 v[64:65], v15 offset:40960
    ds_read_b64_tr_b16 v[66:67], v15 offset:41472
    s_waitcnt lgkmcnt(0)
    v_mfma_f32_16x16x32_bf16 v[28:31], v[60:63], v[44:47], v[28:31]
    ds_read_b128 v[68:71], v16 offset:8192
    ds_read_b128 v[72:75], v16 offset:10240
    v_mfma_f32_16x16x32_bf16 v[40:43], v[60:63], v[48:51], v[40:43]
    ds_read_b64_tr_b16 v[84:85], v15 offset:33792
    ds_read_b64_tr_b16 v[86:87], v15 offset:34304
    v_mfma_f32_16x16x32_bf16 v[28:31], v[64:67], v[52:55], v[28:31]
    ds_read_b128 v[76:79], v17 offset:8192
    ds_read_b128 v[80:83], v17 offset:10240
    v_mfma_f32_16x16x32_bf16 v[40:43], v[64:67], v[56:59], v[40:43]
    ds_read_b64_tr_b16 v[88:89], v15 offset:41984
    ds_read_b64_tr_b16 v[90:91], v15 offset:42496
    v_add_u32 v16, s55, v18
    v_add_u32 v17, s55, v19
    s_add_u32 s55, s55, 16384
    s_and_b32 s55, s55, 0xffff
    s_waitcnt vmcnt(0) lgkmcnt(0)
    s_barrier
    v_mfma_f32_16x16x32_bf16 v[28:31], v[84:87], v[68:71], v[28:31]
    ds_read_b128 v[44:47], v16
    ds_read_b128 v[48:51], v16 offset:2048
    v_mfma_f32_16x16x32_bf16 v[40:43], v[84:87], v[72:75], v[40:43]
    ds_read_b64_tr_b16 v[60:61], v15 offset:49152
    ds_read_b64_tr_b16 v[62:63], v15 offset:49664
    v_mfma_f32_16x16x32_bf16 v[28:31], v[88:91], v[76:79], v[28:31]
    ds_read_b128 v[52:55], v17
    ds_read_b128 v[56:59], v17 offset:2048
    v_mfma_f32_16x16x32_bf16 v[40:43], v[88:91], v[80:83], v[40:43]
    ds_read_b64_tr_b16 v[64:65], v15 offset:57344
    ds_read_b64_tr_b16 v[66:67], v15 offset:57856
    s_waitcnt lgkmcnt(0)
    v_mfma_f32_16x16x32_bf16 v[28:31], v[60:63], v[44:47], v[28:31]
    ds_read_b128 v[68:71], v16 offset:8192
    ds_read_b128 v[72:75], v16 offset:10240
    v_mfma_f32_16x16x32_bf16 v[40:43], v[60:63], v[48:51], v[40:43]
    ds_read_b64_tr_b16 v[84:85], v15 offset:50176
    ds_read_b64_tr_b16 v[86:87], v15 offset:50688
    v_mfma_f32_16x16x32_bf16 v[28:31], v[64:67], v[52:55], v[28:31]
    ds_read_b128 v[76:79], v17 offset:8192
    ds_read_b128 v[80:83], v17 offset:10240
    v_mfma_f32_16x16x32_bf16 v[40:43], v[64:67], v[56:59], v[40:43]
    ds_read_b64_tr_b16 v[88:89], v15 offset:58368
    ds_read_b64_tr_b16 v[90:91], v15 offset:58880
    s_waitcnt lgkmcnt(4)
    v_mfma_f32_16x16x32_bf16 v[28:31], v[84:87], v[68:71], v[28:31]
    v_mfma_f32_16x16x32_bf16 v[40:43], v[84:87], v[72:75], v[40:43]
    s_waitcnt lgkmcnt(0)
    v_mfma_f32_16x16x32_bf16 v[28:31], v[88:91], v[76:79], v[28:31]
    v_mfma_f32_16x16x32_bf16 v[40:43], v[88:91], v[80:83], v[40:43]
    v_mfma_f32_32x32x16_bf16 v[48:63], v[148:151], v[148:151], 0
    v_mfma_f32_32x32x16_bf16 v[64:79], v[148:151], v[148:151], 0
    s_setprio 3
    s_nop 4
    v_pk_mul_f32 v[28:29], v[28:29], s[46:47] op_sel_hi:[1,0]
    v_pk_mul_f32 v[30:31], v[30:31], s[46:47] op_sel_hi:[1,0]
    v_pk_mul_f32 v[40:41], v[40:41], s[46:47] op_sel_hi:[1,0]
    v_pk_mul_f32 v[42:43], v[42:43], s[46:47] op_sel_hi:[1,0]
    v_cvt_pk_bf16_f32 v80, v28, v29
    v_cvt_pk_bf16_f32 v81, v30, v31
    v_cvt_pk_bf16_f32 v82, v40, v41
    v_cvt_pk_bf16_f32 v83, v42, v43
    s_nop 1
    v_permlane16_swap_b32 v80, v82
    v_permlane16_swap_b32 v81, v83
    s_nop 0
    ds_write_b128 v2, v[80:83]
    v_mfma_f32_32x32x16_bf16 v[16:31], v[92:95], v[80:83], 0
    s_waitcnt lgkmcnt(0)
    s_barrier
    ds_read_b128 v[140:143], v4
    ds_read_b128 v[84:87], v3
    ds_read_b64 v[6:7], v5
    s_nop 3
    s_waitcnt lgkmcnt(2)
    v_cmp_gt_i32 vcc, 0, v143
    s_cbranch_vccnz Lt1
    s_call_b64 s[16:17], Lld3
Lt1:
    v_exp_f32 v16, v16
    v_exp_f32 v17, v17
    v_exp_f32 v18, v18
    v_exp_f32 v19, v19
    v_exp_f32 v20, v20
    s_waitcnt lgkmcnt(0)
    v_mfma_f32_32x32x16_bf16 v[32:47], v[92:95], v[84:87], 0
    v_exp_f32 v21, v21
    v_exp_f32 v22, v22
    v_exp_f32 v23, v23
    v_exp_f32 v24, v24
    v_exp_f32 v25, v25
    v_smfmac_f32_32x32x32_bf16 v[48:63], v[96:99], v[16:23], v8
    v_exp_f32 v26, v26
    v_exp_f32 v27, v27
    v_exp_f32 v28, v28
    v_exp_f32 v29, v29
    v_exp_f32 v30, v30
    ds_read_b128 v[140:143], v4
    v_exp_f32 v31, v31
    s_cmp_lg_u32 s47, 0
    s_cbranch_scc1 Lt2
    s_waitcnt lgkmcnt(0)
    v_cmp_gt_i32 vcc, 0, v143
    s_cbranch_vccnz Lt2
    s_call_b64 s[16:17], Lld3
Lt2:
    v_exp_f32 v32, v32
    v_exp_f32 v33, v33
    v_smfmac_f32_32x32x32_bf16 v[48:63], v[100:103], v[24:31], v8
    v_exp_f32 v34, v34
    v_exp_f32 v35, v35
    v_exp_f32 v36, v36
    v_exp_f32 v37, v37
    v_exp_f32 v38, v38
    v_exp_f32 v39, v39
    v_exp_f32 v40, v40
    v_exp_f32 v41, v41
    v_smfmac_f32_32x32x32_bf16 v[64:79], v[96:99], v[32:39], v8
    v_exp_f32 v42, v42
    v_exp_f32 v43, v43
    v_exp_f32 v44, v44
    v_exp_f32 v45, v45
    v_exp_f32 v46, v46
    ds_read_b128 v[140:143], v4
    v_exp_f32 v47, v47
    s_cmp_eq_u32 s47, 0
    s_cbranch_scc1 Lpoll
Lpollend:
    s_mov_b32 s47, 0
    s_waitcnt vmcnt(6)
    v_mfma_f32_32x32x16_bf16 v[16:31], v[104:107], v[80:83], 0
    s_nop 11
.p2align 6
Lloop:
    s_bitcmp1_b32 s59, s47
    s_cbranch_scc1 Lside
Lsideback:
    s_waitcnt lgkmcnt(0)
    v_cmp_gt_i32 vcc, 0, v143
    v_add_u32 v4, 16, v4
    s_cbranch_vccnz Llwait
Llok:
    v_add_u32 v144, v9, v140
    v_add_u32 v145, v9, v141
    v_add_u32 v146, v9, v142
    v_add_u32 v147, v9, v143
    ds_read_b128 v[140:143], v4
    v_exp_f32 v16, v16
    v_exp_f32 v17, v17
    v_smfmac_f32_32x32x32_bf16 v[64:79], v[100:103], v[40:47], v8
    v_exp_f32 v18, v18
    v_exp_f32 v19, v19
    v_exp_f32 v20, v20
    v_mfma_f32_32x32x16_bf16 v[32:47], v[104:107], v[84:87], 0
    v_exp_f32 v21, v21
    v_exp_f32 v22, v22
    v_exp_f32 v23, v23
    v_exp_f32 v24, v24
    v_exp_f32 v25, v25
    v_smfmac_f32_32x32x32_bf16 v[48:63], v[108:111], v[16:23], v8
    v_exp_f32 v26, v26
    buffer_load_dwordx4 v[92:95], v144, s[32:35], 0 offen sc1
    s_mov_b64 exec, s[44:45]
    buffer_load_dwordx4 v[96:99], v144, s[32:35], 0 offen offset:1024 sc1
    buffer_load_dwordx4 v[100:103], v144, s[32:35], 0 offen offset:1280 sc1
    s_mov_b64 exec, -1
    v_exp_f32 v27, v27
    v_exp_f32 v28, v28
    v_exp_f32 v29, v29
    v_exp_f32 v30, v30
    v_exp_f32 v31, v31
    v_exp_f32 v32, v32
    v_exp_f32 v33, v33
    v_smfmac_f32_32x32x32_bf16 v[48:63], v[112:115], v[24:31], v8
    v_exp_f32 v34, v34
    v_exp_f32 v35, v35
    v_exp_f32 v36, v36
    s_waitcnt vmcnt(6)
    v_mfma_f32_32x32x16_bf16 v[16:31], v[116:119], v[80:83], 0
    v_exp_f32 v37, v37
    v_exp_f32 v38, v38
    v_exp_f32 v39, v39
    v_exp_f32 v40, v40
    v_exp_f32 v41, v41
    v_smfmac_f32_32x32x32_bf16 v[64:79], v[108:111], v[32:39], v8
    v_exp_f32 v42, v42
    v_exp_f32 v43, v43
    v_exp_f32 v44, v44
    v_exp_f32 v45, v45
    v_exp_f32 v46, v46
    v_exp_f32 v47, v47
    v_exp_f32 v16, v16
    v_exp_f32 v17, v17
    v_smfmac_f32_32x32x32_bf16 v[64:79], v[112:115], v[40:47], v8
    v_exp_f32 v18, v18
    v_exp_f32 v19, v19
    v_exp_f32 v20, v20
    v_mfma_f32_32x32x16_bf16 v[32:47], v[116:119], v[84:87], 0
    v_exp_f32 v21, v21
    v_exp_f32 v22, v22
    v_exp_f32 v23, v23
    v_exp_f32 v24, v24
    v_exp_f32 v25, v25
    v_smfmac_f32_32x32x32_bf16 v[48:63], v[120:123], v[16:23], v8
    v_exp_f32 v26, v26
    buffer_load_dwordx4 v[104:107], v145, s[32:35], 0 offen sc1
    s_mov_b64 exec, s[44:45]
    buffer_load_dwordx4 v[108:111], v145, s[32:35], 0 offen offset:1024 sc1
    buffer_load_dwordx4 v[112:115], v145, s[32:35], 0 offen offset:1280 sc1
    s_mov_b64 exec, -1
    v_exp_f32 v27, v27
    v_exp_f32 v28, v28
    v_exp_f32 v29, v29
    v_exp_f32 v30, v30
    v_exp_f32 v31, v31
    v_exp_f32 v32, v32
    v_exp_f32 v33, v33
    v_smfmac_f32_32x32x32_bf16 v[48:63], v[124:127], v[24:31], v8
    v_exp_f32 v34, v34
    v_exp_f32 v35, v35
    v_exp_f32 v36, v36
    s_waitcnt vmcnt(6)
    v_mfma_f32_32x32x16_bf16 v[16:31], v[128:131], v[80:83], 0
    v_exp_f32 v37, v37
    v_exp_f32 v38, v38
    v_exp_f32 v39, v39
    v_exp_f32 v40, v40
    v_exp_f32 v41, v41
    v_smfmac_f32_32x32x32_bf16 v[64:79], v[120:123], v[32:39], v8
    v_exp_f32 v42, v42
    v_exp_f32 v43, v43
    v_exp_f32 v44, v44
    v_exp_f32 v45, v45
    v_exp_f32 v46, v46
    v_exp_f32 v47, v47
    v_exp_f32 v16, v16
    v_exp_f32 v17, v17
    v_smfmac_f32_32x32x32_bf16 v[64:79], v[124:127], v[40:47], v8
    v_exp_f32 v18, v18
    v_exp_f32 v19, v19
    v_exp_f32 v20, v20
    v_mfma_f32_32x32x16_bf16 v[32:47], v[128:131], v[84:87], 0
    v_exp_f32 v21, v21
    v_exp_f32 v22, v22
    v_exp_f32 v23, v23
    v_exp_f32 v24, v24
    v_exp_f32 v25, v25
    v_smfmac_f32_32x32x32_bf16 v[48:63], v[132:135], v[16:23], v8
    v_exp_f32 v26, v26
    buffer_load_dwordx4 v[116:119], v146, s[32:35], 0 offen sc1
    s_mov_b64 exec, s[44:45]
    buffer_load_dwordx4 v[120:123], v146, s[32:35], 0 offen offset:1024 sc1
    buffer_load_dwordx4 v[124:127], v146, s[32:35], 0 offen offset:1280 sc1
    s_mov_b64 exec, -1
    v_exp_f32 v27, v27
    v_exp_f32 v28, v28
    v_exp_f32 v29, v29
    v_exp_f32 v30, v30
    v_exp_f32 v31, v31
    v_exp_f32 v32, v32
    v_exp_f32 v33, v33
    v_smfmac_f32_32x32x32_bf16 v[48:63], v[136:139], v[24:31], v8
    v_exp_f32 v34, v34
    v_exp_f32 v35, v35
    v_exp_f32 v36, v36
    s_waitcnt vmcnt(6)
    v_mfma_f32_32x32x16_bf16 v[16:31], v[92:95], v[80:83], 0
    v_exp_f32 v37, v37
    v_exp_f32 v38, v38
    v_exp_f32 v39, v39
    v_exp_f32 v40, v40
    v_exp_f32 v41, v41
    v_smfmac_f32_32x32x32_bf16 v[64:79], v[132:135], v[32:39], v8
    v_exp_f32 v42, v42
    v_exp_f32 v43, v43
    v_exp_f32 v44, v44
    v_exp_f32 v45, v45
    v_exp_f32 v46, v46
    v_exp_f32 v47, v47
    v_exp_f32 v16, v16
    v_exp_f32 v17, v17
    v_smfmac_f32_32x32x32_bf16 v[64:79], v[136:139], v[40:47], v8
    v_exp_f32 v18, v18
    v_exp_f32 v19, v19
    v_exp_f32 v20, v20
    v_mfma_f32_32x32x16_bf16 v[32:47], v[92:95], v[84:87], 0
    v_exp_f32 v21, v21
    v_exp_f32 v22, v22
    v_exp_f32 v23, v23
    v_exp_f32 v24, v24
    v_exp_f32 v25, v25
    v_smfmac_f32_32x32x32_bf16 v[48:63], v[96:99], v[16:23], v8
    v_exp_f32 v26, v26
    buffer_load_dwordx4 v[128:131], v147, s[32:35], 0 offen sc1
    s_mov_b64 exec, s[44:45]
    buffer_load_dwordx4 v[132:135], v147, s[32:35], 0 offen offset:1024 sc1
    buffer_load_dwordx4 v[136:139], v147, s[32:35], 0 offen offset:1280 sc1
    s_mov_b64 exec, -1
    v_exp_f32 v27, v27
    v_exp_f32 v28, v28
    v_exp_f32 v29, v29
    v_exp_f32 v30, v30
    v_exp_f32 v31, v31
    v_exp_f32 v32, v32
    v_exp_f32 v33, v33
    v_smfmac_f32_32x32x32_bf16 v[48:63], v[100:103], v[24:31], v8
    v_exp_f32 v34, v34
    v_exp_f32 v35, v35
    v_exp_f32 v36, v36
    s_waitcnt vmcnt(6)
    v_mfma_f32_32x32x16_bf16 v[16:31], v[104:107], v[80:83], 0
    v_exp_f32 v37, v37
    v_exp_f32 v38, v38
    v_exp_f32 v39, v39
    v_exp_f32 v40, v40
    v_exp_f32 v41, v41
    v_smfmac_f32_32x32x32_bf16 v[64:79], v[96:99], v[32:39], v8
    v_exp_f32 v42, v42
    v_exp_f32 v43, v43
    v_exp_f32 v44, v44
    v_exp_f32 v45, v45
    v_exp_f32 v46, v46
    v_exp_f32 v47, v47
    s_add_u32 s47, s47, 1
    s_cmp_lt_u32 s47, 7
    s_cbranch_scc1 Lloop
    s_mov_b64 exec, 0xff
    buffer_load_dwordx2 v[14:15], v12, s[60:63], 0 offen sc1
    s_mov_b64 exec, -1
    s_lshl_b32 s16, s21, 1
    s_lshr_b32 s55, s20, 2
    s_add_u32 s50, s16, s55
    s_lshl_b32 s16, s50, 15
    s_lshl_b32 s17, s22, 12
    s_add_u32 s51, s16, s17
    v_exp_f32 v16, v16
    v_exp_f32 v17, v17
    v_smfmac_f32_32x32x32_bf16 v[64:79], v[100:103], v[40:47], v8
    v_exp_f32 v18, v18
    v_exp_f32 v19, v19
    v_exp_f32 v20, v20
    v_mfma_f32_32x32x16_bf16 v[32:47], v[104:107], v[84:87], 0
    v_exp_f32 v21, v21
    v_exp_f32 v22, v22
    v_exp_f32 v23, v23
    v_exp_f32 v24, v24
    v_exp_f32 v25, v25
    v_smfmac_f32_32x32x32_bf16 v[48:63], v[108:111], v[16:23], v8
    v_exp_f32 v26, v26
    v_exp_f32 v27, v27
    v_exp_f32 v28, v28
    v_exp_f32 v29, v29
    v_exp_f32 v30, v30
    v_exp_f32 v31, v31
    v_exp_f32 v32, v32
    v_exp_f32 v33, v33
    v_smfmac_f32_32x32x32_bf16 v[48:63], v[112:115], v[24:31], v8
    v_exp_f32 v34, v34
    v_exp_f32 v35, v35
    v_exp_f32 v36, v36
    s_waitcnt vmcnt(4)
    v_mfma_f32_32x32x16_bf16 v[16:31], v[116:119], v[80:83], 0
    v_exp_f32 v37, v37
    v_exp_f32 v38, v38
    v_exp_f32 v39, v39
    v_exp_f32 v40, v40
    v_exp_f32 v41, v41
    v_smfmac_f32_32x32x32_bf16 v[64:79], v[108:111], v[32:39], v8
    v_exp_f32 v42, v42
    v_exp_f32 v43, v43
    v_exp_f32 v44, v44
    v_exp_f32 v45, v45
    v_exp_f32 v46, v46
    v_exp_f32 v47, v47
    s_setprio 1
    v_exp_f32 v16, v16
    v_exp_f32 v17, v17
    v_smfmac_f32_32x32x32_bf16 v[64:79], v[112:115], v[40:47], v8
    v_exp_f32 v18, v18
    v_exp_f32 v19, v19
    v_exp_f32 v20, v20
    v_mfma_f32_32x32x16_bf16 v[32:47], v[116:119], v[84:87], 0
    v_exp_f32 v21, v21
    v_exp_f32 v22, v22
    v_exp_f32 v23, v23
    v_exp_f32 v24, v24
    v_exp_f32 v25, v25
    v_smfmac_f32_32x32x32_bf16 v[48:63], v[120:123], v[16:23], v8
    v_exp_f32 v26, v26
    v_exp_f32 v27, v27
    v_exp_f32 v28, v28
    v_exp_f32 v29, v29
    v_exp_f32 v30, v30
    v_exp_f32 v31, v31
    v_exp_f32 v32, v32
    v_exp_f32 v33, v33
    v_smfmac_f32_32x32x32_bf16 v[48:63], v[124:127], v[24:31], v8
    v_exp_f32 v34, v34
    v_exp_f32 v35, v35
    v_exp_f32 v36, v36
    s_waitcnt vmcnt(0)
    v_mfma_f32_32x32x16_bf16 v[16:31], v[128:131], v[84:87], 0
    v_exp_f32 v37, v37
    v_exp_f32 v38, v38
    v_exp_f32 v39, v39
    v_exp_f32 v40, v40
    v_exp_f32 v41, v41
    v_smfmac_f32_32x32x32_bf16 v[64:79], v[120:123], v[32:39], v8
    v_exp_f32 v42, v42
    v_exp_f32 v43, v43
    v_exp_f32 v44, v44
    v_exp_f32 v45, v45
    v_exp_f32 v46, v46
    v_exp_f32 v47, v47
    v_cmp_ne_u64 vcc, v[6:7], v[14:15]
    s_cmp_eq_u32 s22, s20
    s_cselect_b32 s52, 1, 0
    s_and_b32 vcc_lo, vcc_lo, 0xff
    s_cbranch_scc1 Lflagwait
Lflagok:
    buffer_load_dwordx4 v[104:107], v1, s[36:39], s51 offen sc1
    buffer_load_dwordx4 v[108:111], v1, s[36:39], s51 offen offset:1024 sc1
    buffer_load_dwordx4 v[112:115], v1, s[36:39], s51 offen offset:2048 sc1
    buffer_load_dwordx4 v[116:119], v1, s[36:39], s51 offen offset:3072 sc1
    v_exp_f32 v16, v16
    v_exp_f32 v17, v17
    v_smfmac_f32_32x32x32_bf16 v[64:79], v[124:127], v[40:47], v8
    v_exp_f32 v18, v18
    v_exp_f32 v19, v19
    v_exp_f32 v20, v20
    v_mfma_f32_32x32x16_bf16 v[32:47], v[128:131], v[80:83], 0
    v_exp_f32 v21, v21
    v_exp_f32 v22, v22
    v_exp_f32 v23, v23
    v_exp_f32 v24, v24
    v_exp_f32 v25, v25
    v_smfmac_f32_32x32x32_bf16 v[64:79], v[132:135], v[16:23], v8
    v_exp_f32 v26, v26
    v_exp_f32 v27, v27
    v_exp_f32 v28, v28
    v_exp_f32 v29, v29
    v_exp_f32 v30, v30
    v_exp_f32 v31, v31
    s_setprio 0
    v_exp_f32 v32, v32
    v_exp_f32 v33, v33
    v_smfmac_f32_32x32x32_bf16 v[64:79], v[136:139], v[24:31], v8
    v_exp_f32 v34, v34
    v_exp_f32 v35, v35
    v_exp_f32 v36, v36
    v_exp_f32 v37, v37
    v_exp_f32 v38, v38
    v_exp_f32 v39, v39
    v_exp_f32 v40, v40
    v_exp_f32 v41, v41
    v_smfmac_f32_32x32x32_bf16 v[48:63], v[132:135], v[32:39], v8
    v_exp_f32 v42, v42
    v_exp_f32 v43, v43
    v_exp_f32 v44, v44
    v_exp_f32 v45, v45
    v_exp_f32 v46, v46
    ds_write_b128 v2, v[64:67]
    ds_write_b128 v2, v[68:71] offset:1024
    ds_write_b32 v2, v72 offset:2048
    v_exp_f32 v47, v47
    s_waitcnt lgkmcnt(0)
    s_nop 0
    v_smfmac_f32_32x32x32_bf16 v[48:63], v[136:139], v[40:47], v8
    s_barrier
    ds_read_b32 v24, v3 offset:2048
    ds_read_b128 v[16:19], v3
    ds_read_b128 v[20:23], v3 offset:1024
    s_lshl_b32 s16, s20, 12
    s_lshl_b32 s17, s23, 10
    s_add_u32 s16, s16, s17
    s_add_u32 s16, s16, 131072
    v_add_u32 v13, s16, v1
    s_nop 2
    s_waitcnt lgkmcnt(2)
    v_add_f32 v56, v56, v24
    v_rcp_f32 v4, v56
    s_waitcnt lgkmcnt(0)
    v_pk_add_f32 v[48:49], v[48:49], v[16:17]
    v_pk_add_f32 v[50:51], v[50:51], v[18:19]
    v_pk_add_f32 v[52:53], v[52:53], v[20:21]
    v_pk_add_f32 v[54:55], v[54:55], v[22:23]
    v_pk_fma_f32 v[24:25], v[48:49], 0, v[56:57] op_sel_hi:[1,0,0]
    v_pk_fma_f32 v[24:25], v[50:51], 0, v[24:25] op_sel_hi:[1,0,1]
    v_pk_fma_f32 v[24:25], v[52:53], 0, v[24:25] op_sel_hi:[1,0,1]
    v_pk_fma_f32 v[24:25], v[54:55], 0, v[24:25] op_sel_hi:[1,0,1]
    v_fma_f32 v5, v25, 0, v24
    v_cmp_nge_f32 vcc, 0x5d800000, v5
    s_mov_b64 s[18:19], vcc
    v_cmp_nle_f32 vcc, 0x21800000, v5
    s_or_b64 vcc, vcc, s[18:19]
    s_cbranch_scc1 Lfallback
Lstore:
    v_pk_mul_f32 v[16:17], v[48:49], v[4:5] op_sel_hi:[1,0]
    v_pk_mul_f32 v[18:19], v[50:51], v[4:5] op_sel_hi:[1,0]
    v_pk_mul_f32 v[20:21], v[52:53], v[4:5] op_sel_hi:[1,0]
    v_pk_mul_f32 v[22:23], v[54:55], v[4:5] op_sel_hi:[1,0]
    v_cvt_pk_bf16_f32 v4, v16, v17
    v_cvt_pk_bf16_f32 v5, v18, v19
    v_cvt_pk_bf16_f32 v6, v20, v21
    v_cvt_pk_bf16_f32 v7, v22, v23
    v_min_u32 v4, -2, v4
    v_min_u32 v5, -2, v5
    v_min_u32 v6, -2, v6
    v_min_u32 v7, -2, v7
    buffer_store_dwordx4 v[4:7], v1, s[36:39], s27 offen sc1
    s_barrier
    s_cmp_lg_u32 s24, s55
    s_cbranch_scc1 Lnoby
    ds_write_b128 v13, v[4:7]
Lnoby:
    v_lshrrev_b32 v8, 5, v0
    v_bfe_u32 v9, v0, 4, 1
    v_bfe_u32 v10, v0, 2, 2
    v_lshl_add_u32 v9, v9, 2, v10
    v_lshl_add_u32 v8, v8, 4, v9
    v_lshlrev_b32 v12, 8, v8
    v_xor_b32 v9, s22, v9
    v_lshl_add_u32 v12, v9, 5, v12
    v_and_b32 v9, 3, v0
    v_lshl_add_u32 v12, v9, 3, v12
    v_add_u32 v13, 65536, v12
    ds_read_b64_tr_b16 v[32:33], v12
    ds_read_b64_tr_b16 v[34:35], v12 offset:2048
    ds_read_b64_tr_b16 v[36:37], v12 offset:8192
    ds_read_b64_tr_b16 v[38:39], v12 offset:10240
    ds_read_b64_tr_b16 v[40:41], v12 offset:16384
    ds_read_b64_tr_b16 v[42:43], v12 offset:18432
    ds_read_b64_tr_b16 v[44:45], v12 offset:24576
    ds_read_b64_tr_b16 v[46:47], v12 offset:26624
    ds_read_b64_tr_b16 v[48:49], v12 offset:32768
    ds_read_b64_tr_b16 v[50:51], v12 offset:34816
    ds_read_b64_tr_b16 v[52:53], v12 offset:40960
    ds_read_b64_tr_b16 v[54:55], v12 offset:43008
    ds_read_b64_tr_b16 v[56:57], v12 offset:49152
    ds_read_b64_tr_b16 v[58:59], v12 offset:51200
    ds_read_b64_tr_b16 v[60:61], v12 offset:57344
    ds_read_b64_tr_b16 v[62:63], v12 offset:59392
    ds_read_b64_tr_b16 v[64:65], v13
    ds_read_b64_tr_b16 v[66:67], v13 offset:2048
    ds_read_b64_tr_b16 v[68:69], v13 offset:8192
    ds_read_b64_tr_b16 v[70:71], v13 offset:10240
    ds_read_b64_tr_b16 v[72:73], v13 offset:16384
    ds_read_b64_tr_b16 v[74:75], v13 offset:18432
    ds_read_b64_tr_b16 v[76:77], v13 offset:24576
    ds_read_b64_tr_b16 v[78:79], v13 offset:26624
    ds_read_b64_tr_b16 v[80:81], v13 offset:32768
    ds_read_b64_tr_b16 v[82:83], v13 offset:34816
    ds_read_b64_tr_b16 v[84:85], v13 offset:40960
    ds_read_b64_tr_b16 v[86:87], v13 offset:43008
    ds_read_b64_tr_b16 v[88:89], v13 offset:49152
    ds_read_b64_tr_b16 v[90:91], v13 offset:51200
    ds_read_b64_tr_b16 v[92:93], v13 offset:57344
    ds_read_b64_tr_b16 v[94:95], v13 offset:59392
    s_mov_b32 s44, s10
    s_mov_b32 s45, s11
    s_mov_b32 s46, 2097152
    s_mov_b32 s47, 0x20000
    v_lshrrev_b32 v8, 5, v0
    v_lshlrev_b32 v14, 10, v8
    v_bfe_u32 v9, v0, 4, 1
    v_lshl_add_u32 v14, v9, 9, v14
    v_and_b32 v9, 15, v0
    v_lshl_add_u32 v14, v9, 4, v14
    v_add_u32 v14, 131072, v14
    v_and_b32 v15, 31, v0
    v_lshlrev_b32 v15, 10, v15
    v_lshl_add_u32 v15, v8, 4, v15
    s_lshl_b32 s16, s50, 15
    s_and_b32 s17, s20, 3
    s_lshl_b32 s17, s17, 8
    s_add_u32 s16, s16, s17
    s_lshl_b32 s17, s22, 5
    s_add_u32 s16, s16, s17
    v_mov_b32 v10, s17
    v_lshlrev_b32 v11, 5, v0
    v_and_b32 v11, 0xe0, v11
    v_mov_b64 v[96:97], 0
    v_mov_b64 v[98:99], 0
    v_mov_b64 v[100:101], 0
    v_mov_b64 v[102:103], 0
    s_mov_b32 s54, 200000
    s_mov_b32 s53, 0
    s_mov_b32 s57, 0
    s_mov_b32 s56, 3200000
    s_waitcnt vmcnt(1)
    s_mov_b32 s55, 1
    s_cmp_lg_u32 s52, 0
    s_cbranch_scc0 Lochk
    v_mov_b32 v8, 1
    ds_write_b32 v10, v8
    s_branch Lostat
Lround:
    ds_read_b32 v9, v11
    s_cmp_lg_u32 s52, 0
    s_cbranch_scc1 Loscan
    s_waitcnt vmcnt(0)
Lochk:
    v_max3_u32 v8, v104, v105, v106
    v_max3_u32 v8, v107, v108, v8
    v_max3_u32 v8, v109, v110, v8
    v_max3_u32 v8, v111, v112, v8
    v_max3_u32 v8, v113, v114, v8
    v_max3_u32 v8, v115, v116, v8
    v_max3_u32 v8, v117, v118, v8
    v_max_u32 v8, v119, v8
    v_cmp_eq_u32 vcc, -1, v8
    s_sub_u32 s54, s54, 1
    s_cbranch_scc1 Logo
    s_cbranch_vccz Logo
    buffer_load_dwordx4 v[104:107], v1, s[36:39], s51 offen sc1
    buffer_load_dwordx4 v[108:111], v1, s[36:39], s51 offen offset:1024 sc1
    buffer_load_dwordx4 v[112:115], v1, s[36:39], s51 offen offset:2048 sc1
    buffer_load_dwordx4 v[116:119], v1, s[36:39], s51 offen offset:3072 sc1
    s_cmp_eq_u32 s55, 0
    s_cbranch_scc1 Loscan
    v_mov_b32 v8, 0
    ds_write_b32 v10, v8
    s_branch Lostat
Logo:
    ds_write_b128 v3, v[104:107]
    ds_write_b128 v3, v[108:111] offset:1024
    ds_write_b128 v3, v[112:115] offset:2048
    ds_write_b128 v3, v[116:119] offset:3072
    v_mov_b32 v8, 1
    s_mov_b32 s52, 1
    ds_write_b32 v10, v8
    s_cmp_eq_u32 s55, 0
    s_cbranch_scc1 Lround
Lostat:
    s_mov_b32 s55, 0
    s_waitcnt lgkmcnt(0)
    s_barrier
    ds_read_b32 v9, v11
Loscan:
    s_waitcnt lgkmcnt(0)
    v_cmp_ne_u32 vcc, 0, v9
    s_nop 0
    s_andn2_b32 s49, vcc_lo, s53
    s_and_b32 s49, s49, 0xff
    s_cbranch_scc0 Lidle
    s_or_b32 s17, s53, s49
    s_cmp_eq_u32 s17, 0xff
    s_cbranch_scc1 Lgo
    s_sub_u32 s57, s57, 1
    s_cbranch_scc0 Lround
Lgo:
    s_mov_b32 s57, 2
    s_mov_b32 s53, s17
    s_bcnt1_i32_b32 s48, s49
    s_cmp_ge_u32 s48, 5
    s_cbranch_scc1 Lbulk
    s_and_b32 s48, s49, 15
    s_cbranch_scc0 Lg1
    s_and_b32 s48, s49, 3
    s_cbranch_scc0 Lg2
    s_bitcmp0_b32 s49, 0
    s_cbranch_scc1 Lg3
    ds_read_b128 v[16:19], v14
    ds_read_b128 v[20:23], v14 offset:256
    ds_read_b128 v[24:27], v14 offset:2048
    ds_read_b128 v[28:31], v14 offset:2304
Lg3:
    s_bitcmp0_b32 s49, 1
    s_cbranch_scc1 Lg4
    ds_read_b128 v[120:123], v14 offset:4096
    ds_read_b128 v[124:127], v14 offset:4352
    ds_read_b128 v[128:131], v14 offset:6144
    ds_read_b128 v[132:135], v14 offset:6400
Lg4:
Lg2:
    s_and_b32 s48, s49, 12
    s_cbranch_scc0 Lg5
    s_bitcmp0_b32 s49, 2
    s_cbranch_scc1 Lg6
    ds_read_b128 v[136:139], v14 offset:8192
    ds_read_b128 v[140:143], v14 offset:8448
    ds_read_b128 v[144:147], v14 offset:10240
    ds_read_b128 v[148:151], v14 offset:10496
Lg6:
    s_bitcmp0_b32 s49, 3
    s_cbranch_scc1 Lg7
    ds_read_b128 v[152:155], v14 offset:12288
    ds_read_b128 v[156:159], v14 offset:12544
    ds_read_b128 v[160:163], v14 offset:14336
    ds_read_b128 v[164:167], v14 offset:14592
Lg7:
Lg5:
    s_waitcnt lgkmcnt(0)
Lg1:
    s_and_b32 s48, s49, 51
    s_cbranch_scc0 Lg8
    s_bitcmp0_b32 s49, 0
    s_cbranch_scc1 Lg9
    v_mfma_f32_16x16x32_bf16 v[96:99], v[32:35], v[16:19], v[96:99]
    v_mfma_f32_16x16x32_bf16 v[100:103], v[32:35], v[20:23], v[100:103]
    v_mfma_f32_16x16x32_bf16 v[96:99], v[36:39], v[24:27], v[96:99]
    v_mfma_f32_16x16x32_bf16 v[100:103], v[36:39], v[28:31], v[100:103]
Lg9:
    s_bitcmp0_b32 s49, 4
    s_cbranch_scc1 Lg10
    ds_read_b128 v[16:19], v14 offset:16384
    ds_read_b128 v[20:23], v14 offset:16640
    ds_read_b128 v[24:27], v14 offset:18432
    ds_read_b128 v[28:31], v14 offset:18688
Lg10:
    s_bitcmp0_b32 s49, 1
    s_cbranch_scc1 Lg11
    v_mfma_f32_16x16x32_bf16 v[96:99], v[40:43], v[120:123], v[96:99]
    v_mfma_f32_16x16x32_bf16 v[100:103], v[40:43], v[124:127], v[100:103]
    v_mfma_f32_16x16x32_bf16 v[96:99], v[44:47], v[128:131], v[96:99]
    v_mfma_f32_16x16x32_bf16 v[100:103], v[44:47], v[132:135], v[100:103]
Lg11:
    s_bitcmp0_b32 s49, 5
    s_cbranch_scc1 Lg12
    ds_read_b128 v[120:123], v14 offset:20480
    ds_read_b128 v[124:127], v14 offset:20736
    ds_read_b128 v[128:131], v14 offset:22528
    ds_read_b128 v[132:135], v14 offset:22784
Lg12:
Lg8:
    s_and_b32 s48, s49, 204
    s_cbranch_scc0 Lg13
    s_bitcmp0_b32 s49, 2
    s_cbranch_scc1 Lg14
    v_mfma_f32_16x16x32_bf16 v[96:99], v[48:51], v[136:139], v[96:99]
    v_mfma_f32_16x16x32_bf16 v[100:103], v[48:51], v[140:143], v[100:103]
    v_mfma_f32_16x16x32_bf16 v[96:99], v[52:55], v[144:147], v[96:99]
    v_mfma_f32_16x16x32_bf16 v[100:103], v[52:55], v[148:151], v[100:103]
Lg14:
    s_bitcmp0_b32 s49, 6
    s_cbranch_scc1 Lg15
    ds_read_b128 v[136:139], v14 offset:24576
    ds_read_b128 v[140:143], v14 offset:24832
    ds_read_b128 v[144:147], v14 offset:26624
    ds_read_b128 v[148:151], v14 offset:26880
Lg15:
    s_bitcmp0_b32 s49, 3
    s_cbranch_scc1 Lg16
    v_mfma_f32_16x16x32_bf16 v[96:99], v[56:59], v[152:155], v[96:99]
    v_mfma_f32_16x16x32_bf16 v[100:103], v[56:59], v[156:159], v[100:103]
    v_mfma_f32_16x16x32_bf16 v[96:99], v[60:63], v[160:163], v[96:99]
    v_mfma_f32_16x16x32_bf16 v[100:103], v[60:63], v[164:167], v[100:103]
Lg16:
    s_bitcmp0_b32 s49, 7
    s_cbranch_scc1 Lg17
    ds_read_b128 v[152:155], v14 offset:28672
    ds_read_b128 v[156:159], v14 offset:28928
    ds_read_b128 v[160:163], v14 offset:30720
    ds_read_b128 v[164:167], v14 offset:30976
Lg17:
Lg13:
    s_and_b32 s48, s49, 240
    s_cbranch_scc0 Lg18
    s_waitcnt lgkmcnt(0)
    s_and_b32 s48, s49, 48
    s_cbranch_scc0 Lg19
    s_bitcmp0_b32 s49, 4
    s_cbranch_scc1 Lg20
    v_mfma_f32_16x16x32_bf16 v[96:99], v[64:67], v[16:19], v[96:99]
    v_mfma_f32_16x16x32_bf16 v[100:103], v[64:67], v[20:23], v[100:103]
    v_mfma_f32_16x16x32_bf16 v[96:99], v[68:71], v[24:27], v[96:99]
    v_mfma_f32_16x16x32_bf16 v[100:103], v[68:71], v[28:31], v[100:103]
Lg20:
    s_bitcmp0_b32 s49, 5
    s_cbranch_scc1 Lg21
    v_mfma_f32_16x16x32_bf16 v[96:99], v[72:75], v[120:123], v[96:99]
    v_mfma_f32_16x16x32_bf16 v[100:103], v[72:75], v[124:127], v[100:103]
    v_mfma_f32_16x16x32_bf16 v[96:99], v[76:79], v[128:131], v[96:99]
    v_mfma_f32_16x16x32_bf16 v[100:103], v[76:79], v[132:135], v[100:103]
Lg21:
Lg19:
    s_and_b32 s48, s49, 192
    s_cbranch_scc0 Lg22
    s_bitcmp0_b32 s49, 6
    s_cbranch_scc1 Lg23
    v_mfma_f32_16x16x32_bf16 v[96:99], v[80:83], v[136:139], v[96:99]
    v_mfma_f32_16x16x32_bf16 v[100:103], v[80:83], v[140:143], v[100:103]
    v_mfma_f32_16x16x32_bf16 v[96:99], v[84:87], v[144:147], v[96:99]
    v_mfma_f32_16x16x32_bf16 v[100:103], v[84:87], v[148:151], v[100:103]
Lg23:
    s_bitcmp0_b32 s49, 7
    s_cbranch_scc1 Lg24
    v_mfma_f32_16x16x32_bf16 v[96:99], v[88:91], v[152:155], v[96:99]
    v_mfma_f32_16x16x32_bf16 v[100:103], v[88:91], v[156:159], v[100:103]
    v_mfma_f32_16x16x32_bf16 v[96:99], v[92:95], v[160:163], v[96:99]
    v_mfma_f32_16x16x32_bf16 v[100:103], v[92:95], v[164:167], v[100:103]
Lg24:
Lg22:
Lg18:
    s_cmp_lg_u32 s53, 0xff
    s_cbranch_scc1 Lround
Lfin:
    s_nop 5
    v_cvt_pk_bf16_f32 v16, v96, v97
    v_cvt_pk_bf16_f32 v17, v98, v99
    v_cvt_pk_bf16_f32 v18, v100, v101
    v_cvt_pk_bf16_f32 v19, v102, v103
    s_nop 1
    v_permlane16_swap_b32 v16, v18
    v_permlane16_swap_b32 v17, v19
    buffer_store_dwordx4 v[16:19], v15, s[44:47], s16 offen
Lend:
    s_endpgm
Lidle:
    s_sleep 2
    s_sub_u32 s56, s56, 1
    s_cbranch_scc0 Lround
    s_branch Lfin
Lbulk:
    ds_read_b128 v[16:19], v14
    ds_read_b128 v[20:23], v14 offset:256
    ds_read_b128 v[24:27], v14 offset:2048
    ds_read_b128 v[28:31], v14 offset:2304
    ds_read_b128 v[120:123], v14 offset:4096
    ds_read_b128 v[124:127], v14 offset:4352
    ds_read_b128 v[128:131], v14 offset:6144
    ds_read_b128 v[132:135], v14 offset:6400
    s_bitcmp0_b32 s49, 0
    s_cbranch_scc1 Lbk0
    s_waitcnt lgkmcnt(4)
    v_mfma_f32_16x16x32_bf16 v[96:99], v[32:35], v[16:19], v[96:99]
    v_mfma_f32_16x16x32_bf16 v[100:103], v[32:35], v[20:23], v[100:103]
    v_mfma_f32_16x16x32_bf16 v[96:99], v[36:39], v[24:27], v[96:99]
    v_mfma_f32_16x16x32_bf16 v[100:103], v[36:39], v[28:31], v[100:103]
Lbk0:
    ds_read_b128 v[136:139], v14 offset:8192
    ds_read_b128 v[140:143], v14 offset:8448
    ds_read_b128 v[144:147], v14 offset:10240
    ds_read_b128 v[148:151], v14 offset:10496
    s_bitcmp0_b32 s49, 1
    s_cbranch_scc1 Lbk1
    s_waitcnt lgkmcnt(4)
    v_mfma_f32_16x16x32_bf16 v[96:99], v[40:43], v[120:123], v[96:99]
    v_mfma_f32_16x16x32_bf16 v[100:103], v[40:43], v[124:127], v[100:103]
    v_mfma_f32_16x16x32_bf16 v[96:99], v[44:47], v[128:131], v[96:99]
    v_mfma_f32_16x16x32_bf16 v[100:103], v[44:47], v[132:135], v[100:103]
Lbk1:
    ds_read_b128 v[152:155], v14 offset:12288
    ds_read_b128 v[156:159], v14 offset:12544
    ds_read_b128 v[160:163], v14 offset:14336
    ds_read_b128 v[164:167], v14 offset:14592
    s_bitcmp0_b32 s49, 2
    s_cbranch_scc1 Lbk2
    s_waitcnt lgkmcnt(4)
    v_mfma_f32_16x16x32_bf16 v[96:99], v[48:51], v[136:139], v[96:99]
    v_mfma_f32_16x16x32_bf16 v[100:103], v[48:51], v[140:143], v[100:103]
    v_mfma_f32_16x16x32_bf16 v[96:99], v[52:55], v[144:147], v[96:99]
    v_mfma_f32_16x16x32_bf16 v[100:103], v[52:55], v[148:151], v[100:103]
Lbk2:
    ds_read_b128 v[16:19], v14 offset:16384
    ds_read_b128 v[20:23], v14 offset:16640
    ds_read_b128 v[24:27], v14 offset:18432
    ds_read_b128 v[28:31], v14 offset:18688
    s_bitcmp0_b32 s49, 3
    s_cbranch_scc1 Lbk3
    s_waitcnt lgkmcnt(4)
    v_mfma_f32_16x16x32_bf16 v[96:99], v[56:59], v[152:155], v[96:99]
    v_mfma_f32_16x16x32_bf16 v[100:103], v[56:59], v[156:159], v[100:103]
    v_mfma_f32_16x16x32_bf16 v[96:99], v[60:63], v[160:163], v[96:99]
    v_mfma_f32_16x16x32_bf16 v[100:103], v[60:63], v[164:167], v[100:103]
Lbk3:
    ds_read_b128 v[120:123], v14 offset:20480
    ds_read_b128 v[124:127], v14 offset:20736
    ds_read_b128 v[128:131], v14 offset:22528
    ds_read_b128 v[132:135], v14 offset:22784
    s_bitcmp0_b32 s49, 4
    s_cbranch_scc1 Lbk4
    s_waitcnt lgkmcnt(4)
    v_mfma_f32_16x16x32_bf16 v[96:99], v[64:67], v[16:19], v[96:99]
    v_mfma_f32_16x16x32_bf16 v[100:103], v[64:67], v[20:23], v[100:103]
    v_mfma_f32_16x16x32_bf16 v[96:99], v[68:71], v[24:27], v[96:99]
    v_mfma_f32_16x16x32_bf16 v[100:103], v[68:71], v[28:31], v[100:103]
Lbk4:
    ds_read_b128 v[136:139], v14 offset:24576
    ds_read_b128 v[140:143], v14 offset:24832
    ds_read_b128 v[144:147], v14 offset:26624
    ds_read_b128 v[148:151], v14 offset:26880
    s_bitcmp0_b32 s49, 5
    s_cbranch_scc1 Lbk5
    s_waitcnt lgkmcnt(4)
    v_mfma_f32_16x16x32_bf16 v[96:99], v[72:75], v[120:123], v[96:99]
    v_mfma_f32_16x16x32_bf16 v[100:103], v[72:75], v[124:127], v[100:103]
    v_mfma_f32_16x16x32_bf16 v[96:99], v[76:79], v[128:131], v[96:99]
    v_mfma_f32_16x16x32_bf16 v[100:103], v[76:79], v[132:135], v[100:103]
Lbk5:
    ds_read_b128 v[152:155], v14 offset:28672
    ds_read_b128 v[156:159], v14 offset:28928
    ds_read_b128 v[160:163], v14 offset:30720
    ds_read_b128 v[164:167], v14 offset:30976
    s_bitcmp0_b32 s49, 6
    s_cbranch_scc1 Lbk6
    s_waitcnt lgkmcnt(4)
    v_mfma_f32_16x16x32_bf16 v[96:99], v[80:83], v[136:139], v[96:99]
    v_mfma_f32_16x16x32_bf16 v[100:103], v[80:83], v[140:143], v[100:103]
    v_mfma_f32_16x16x32_bf16 v[96:99], v[84:87], v[144:147], v[96:99]
    v_mfma_f32_16x16x32_bf16 v[100:103], v[84:87], v[148:151], v[100:103]
Lbk6:
    s_bitcmp0_b32 s49, 7
    s_cbranch_scc1 Lbk7
    s_waitcnt lgkmcnt(0)
    v_mfma_f32_16x16x32_bf16 v[96:99], v[88:91], v[152:155], v[96:99]
    v_mfma_f32_16x16x32_bf16 v[100:103], v[88:91], v[156:159], v[100:103]
    v_mfma_f32_16x16x32_bf16 v[96:99], v[92:95], v[160:163], v[96:99]
    v_mfma_f32_16x16x32_bf16 v[100:103], v[92:95], v[164:167], v[100:103]
Lbk7:
    s_waitcnt lgkmcnt(0)
    s_cmp_lg_u32 s53, 0xff
    s_cbranch_scc0 Lfin
    s_branch Lround
Lside:
    s_cmp_lg_u32 s47, 6
    s_cbranch_scc1 Lside1
    s_setprio 2
    s_sub_u32 s16, s47, 2
    s_cmp_ge_u32 s16, 4
    s_cbranch_scc1 Lsideback
Lside1:
    s_lshr_b32 s16, s53, 2
    s_add_u32 m0, s48, s16
    s_add_u32 s16, s53, 8192
    buffer_load_dwordx4 v10, s[40:43], s53 offen lds
    buffer_load_dwordx4 v11, s[40:43], s53 offen offset:1024 lds
    s_and_b32 s53, s16, 0xffff
    s_lshr_b32 s16, s53, 2
    s_add_u32 m0, s48, s16
    s_add_u32 s16, s53, 8192
    buffer_load_dwordx4 v10, s[40:43], s53 offen lds
    buffer_load_dwordx4 v11, s[40:43], s53 offen offset:1024 lds
    s_and_b32 s53, s16, 0xffff
    s_branch Lsideback
Lld3:
    v_add_u32 v144, v9, v141
    v_add_u32 v145, v9, v142
    v_add_u32 v146, v9, v143
    v_add_u32 v4, 16, v4
    buffer_load_dwordx4 v[104:107], v144, s[32:35], 0 offen sc1
    s_mov_b64 exec, s[44:45]
    buffer_load_dwordx4 v[108:111], v144, s[32:35], 0 offen offset:1024 sc1
    buffer_load_dwordx4 v[112:115], v144, s[32:35], 0 offen offset:1280 sc1
    s_mov_b64 exec, -1
    buffer_load_dwordx4 v[116:119], v145, s[32:35], 0 offen sc1
    s_mov_b64 exec, s[44:45]
    buffer_load_dwordx4 v[120:123], v145, s[32:35], 0 offen offset:1024 sc1
    buffer_load_dwordx4 v[124:127], v145, s[32:35], 0 offen offset:1280 sc1
    s_mov_b64 exec, -1
    buffer_load_dwordx4 v[128:131], v146, s[32:35], 0 offen sc1
    s_mov_b64 exec, s[44:45]
    buffer_load_dwordx4 v[132:135], v146, s[32:35], 0 offen offset:1024 sc1
    buffer_load_dwordx4 v[136:139], v146, s[32:35], 0 offen offset:1280 sc1
    s_mov_b64 exec, -1
    s_mov_b32 s47, 1
    s_setpc_b64 s[16:17]
Lpoll:
    s_mov_b32 s54, 1600000
Lpolla:
    s_waitcnt lgkmcnt(0)
    v_cmp_gt_i32 vcc, 0, v143
    s_sub_u32 s54, s54, 1
    s_cbranch_scc1 Lpollb
    s_cbranch_vccz Lpollb
    ds_read_b128 v[140:143], v4
    s_branch Lpolla
Lpollb:
    s_call_b64 s[16:17], Lld3
    ds_read_b128 v[140:143], v4
    s_branch Lpollend
Llwait:
    s_mov_b32 s54, 1600000
    v_add_u32 v14, -16, v4
Llwaita:
    ds_read_b128 v[140:143], v14
    s_waitcnt lgkmcnt(0)
    v_cmp_gt_i32 vcc, 0, v143
    s_sub_u32 s54, s54, 1
    s_cbranch_scc1 Llok
    s_cbranch_vccnz Llwaita
    s_branch Llok
Lflagwait:
    s_mov_b32 s54, 200000
    s_mov_b64 exec, 0xff
Lflagwait1:
    s_sleep 4
    buffer_load_dwordx2 v[14:15], v12, s[60:63], 0 offen sc1
    s_waitcnt vmcnt(0)
    v_cmp_ne_u64 vcc, v[6:7], v[14:15]
    s_sub_u32 s54, s54, 1
    s_cbranch_scc1 Lflagwait2
    s_cbranch_vccnz Lflagwait1
Lflagwait2:
    s_mov_b64 exec, -1
    s_branch Lflagok
Lfallback:
    s_lshl_b32 s16, s25, 17
    s_add_u32 s17, s16, 131072
    v_mov_b32 v4, 0xff800000
Lmax:
    buffer_load_dwordx4 v[92:95], v1, s[32:35], s16 offen sc1
    s_waitcnt vmcnt(0)
    v_mfma_f32_32x32x16_bf16 v[16:31], v[92:95], v[80:83], 0
    s_add_u32 s16, s16, 2048
    s_nop 15
    v_max3_f32 v4, v16, v17, v4
    v_max3_f32 v4, v18, v19, v4
    v_max3_f32 v4, v20, v21, v4
    v_max3_f32 v4, v22, v23, v4
    v_max3_f32 v4, v24, v25, v4
    v_max3_f32 v4, v26, v27, v4
    v_max3_f32 v4, v28, v29, v4
    v_max3_f32 v4, v30, v31, v4
    s_cmp_lt_u32 s16, s17
    s_cbranch_scc1 Lmax
    v_mov_b32 v5, v4
    s_nop 1
    v_permlane32_swap_b32 v4, v5
    s_nop 1
    v_max_f32 v4, v4, v5
    s_sub_u32 s16, s17, 131072
    v_sub_f32 v64, 0, v4
    v_mov_b32 v48, 0
    v_sub_f32 v65, 0, v4
    v_mov_b32 v49, 0
    v_sub_f32 v66, 0, v4
    v_mov_b32 v50, 0
    v_sub_f32 v67, 0, v4
    v_mov_b32 v51, 0
    v_sub_f32 v68, 0, v4
    v_mov_b32 v52, 0
    v_sub_f32 v69, 0, v4
    v_mov_b32 v53, 0
    v_sub_f32 v70, 0, v4
    v_mov_b32 v54, 0
    v_sub_f32 v71, 0, v4
    v_mov_b32 v55, 0
    v_sub_f32 v72, 0, v4
    v_mov_b32 v56, 0
    v_sub_f32 v73, 0, v4
    v_mov_b32 v57, 0
    v_sub_f32 v74, 0, v4
    v_mov_b32 v58, 0
    v_sub_f32 v75, 0, v4
    v_mov_b32 v59, 0
    v_sub_f32 v76, 0, v4
    v_mov_b32 v60, 0
    v_sub_f32 v77, 0, v4
    v_mov_b32 v61, 0
    v_sub_f32 v78, 0, v4
    v_mov_b32 v62, 0
    v_sub_f32 v79, 0, v4
    v_mov_b32 v63, 0
Lredo:
    buffer_load_dwordx4 v[92:95], v1, s[32:35], s16 offen sc1
    s_mov_b64 exec, s[44:45]
    buffer_load_dwordx4 v[96:99], v1, s[32:35], s16 offen offset:1024 sc1
    buffer_load_dwordx4 v[100:103], v1, s[32:35], s16 offen offset:1280 sc1
    s_mov_b64 exec, -1
    s_waitcnt vmcnt(0)
    v_mfma_f32_32x32x16_bf16 v[16:31], v[92:95], v[80:83], v[64:79]
    s_add_u32 s16, s16, 2048
    s_nop 15
    v_exp_f32 v16, v16
    v_exp_f32 v17, v17
    v_exp_f32 v18, v18
    v_exp_f32 v19, v19
    v_exp_f32 v20, v20
    v_exp_f32 v21, v21
    v_exp_f32 v22, v22
    v_exp_f32 v23, v23
    v_exp_f32 v24, v24
    v_exp_f32 v25, v25
    v_exp_f32 v26, v26
    v_exp_f32 v27, v27
    v_exp_f32 v28, v28
    v_exp_f32 v29, v29
    v_exp_f32 v30, v30
    v_exp_f32 v31, v31
    s_nop 1
    v_smfmac_f32_32x32x32_bf16 v[48:63], v[96:99], v[16:23], v8
    v_smfmac_f32_32x32x32_bf16 v[48:63], v[100:103], v[24:31], v8
    s_cmp_lt_u32 s16, s17
    s_nop 7
    s_cbranch_scc1 Lredo
    s_nop 7
    v_rcp_f32 v4, v56
    s_branch Lstore
.fill 1536, 4, 0xbf800000
.section .rodata,"a"
.p2align 6
.amdhsa_kernel standalone__mha_block__prompt_kernel
  .amdhsa_next_free_vgpr 168
  .amdhsa_next_free_sgpr 64
  .amdhsa_accum_offset 168
  .amdhsa_group_segment_fixed_size 0
  .amdhsa_kernarg_size 48
  .amdhsa_user_sgpr_count 2
  .amdhsa_user_sgpr_kernarg_segment_ptr 1
  .amdhsa_system_sgpr_workgroup_id_x 1
.end_amdhsa_kernel
```
